```python
import torch

def _softmax(x, axis=-1):
    return torch.softmax(x, dim=axis)
def _gelu(x):
    return torch.nn.functional.gelu(x, approximate="tanh")
def _silu(x):
    return torch.nn.functional.silu(x)
def _sigmoid(x):
    return torch.sigmoid(x)
def _layernorm(x, axis=-1, eps=1e-5):
    m = x.mean(dim=axis, keepdim=True)
    v = x.var(dim=axis, keepdim=True, unbiased=False)
    return (x - m) / torch.sqrt(v + eps)
def _scatter_add(tgt, idx, src, axis=0):
    return tgt.clone().index_add_(axis, idx, src)
def _segment_sum(src, seg, n):
    out = torch.zeros((n,) + src.shape[1:], dtype=src.dtype)
    return out.index_add_(0, seg, src)
def _pad(x, pw):
    flat = tuple(v for pair in reversed(pw) for v in pair)
    return torch.nn.functional.pad(x, flat)

kernel_name = 'gated_mix__compressed_kv_cla__dense_activation_gelu__decode'

def setup_inputs():

    _w = (lambda a: (lambda t: t.to(torch.bfloat16) if t.is_floating_point() else t)(torch.as_tensor(a)))
    def _A_setup():
        B, H, Sq, Sk, D, M = 2, 32, 1, 4096, 128, 576
        Dc = 4 * D
        return {
            "x": _w((lambda *s: torch.randn(*s, dtype=torch.bfloat16) * 0.05)(B, Sq, M)),
            "c_kv": _w((lambda *s: torch.randn(*s, dtype=torch.bfloat16) * 0.8)(B, Sk, Dc)),
            "w_q": _w((lambda *s: torch.randn(*s, dtype=torch.bfloat16) * 6.4)(M, H, D) * (M ** -0.5)),
            "w_uk": _w((lambda *s: torch.randn(*s, dtype=torch.bfloat16) * 6.4)(Dc, H, D) * (Dc ** -0.5)),
            "w_uv": _w((lambda *s: torch.randn(*s, dtype=torch.bfloat16) * 0.8)(Dc, H, D) * (Dc ** -0.5)),
            "w_o": _w((lambda *s: torch.randn(*s, dtype=torch.bfloat16) * 0.8)(H, D, M) * ((H * D) ** -0.5)),
        }
    _A_in = _A_setup()

    def _B_setup():
        B, S, D, F = 2, 1, 576, 4608
        return {
            "x": _w((lambda *s: torch.randn(*s, dtype=torch.bfloat16) * 0.05)(B, S, D)),
            "w1": _w((lambda *s: torch.randn(*s, dtype=torch.bfloat16) * 3.2)(D, F) * (D ** -0.5)),
            "b1": _w((lambda *s: torch.randn(*s, dtype=torch.bfloat16) * 3.2)(F) * 0.01),
            "w2": _w((lambda *s: torch.randn(*s, dtype=torch.bfloat16) * 0.8)(F, D) * (F ** -0.5)),
            "b2": _w((lambda *s: torch.randn(*s, dtype=torch.bfloat16) * 1.6)(D) * 0.01),
        }
    _B_in = _B_setup()

    return {
        "A_x": _A_in["x"],
        "A_c_kv": _A_in["c_kv"],
        "A_w_q": _A_in["w_q"],
        "A_w_uk": _A_in["w_uk"],
        "A_w_uv": _A_in["w_uv"],
        "A_w_o": _A_in["w_o"],
        "B_x": _B_in["x"],
        "B_w1": _B_in["w1"],
        "B_b1": _B_in["b1"],
        "B_w2": _B_in["w2"],
        "B_b2": _B_in["b2"],
        "gate_w": _w((lambda *s: torch.randn(*s, dtype=torch.bfloat16) * 0.05)(576) * 16.0),
    }

def reference(A_x, A_c_kv, A_w_q, A_w_uk, A_w_uv, A_w_o, B_x, B_w1, B_b1, B_w2, B_b2, gate_w):
    def _A_ref(x, c_kv, w_q, w_uk, w_uv, w_o):
        B, Sq, M = x.shape[0], x.shape[1], x.shape[2]
        Sk = c_kv.shape[1]
        H, D = w_q.shape[1], w_q.shape[2]
        q = torch.einsum("bqm,mhd->bhqd", x, w_q)
        k = torch.einsum("bkc,chd->bhkd", c_kv, w_uk)
        v = torch.einsum("bkc,chd->bhkd", c_kv, w_uv)
        scores = torch.einsum("bhqd,bhkd->bhqk", q, k) * (D ** -0.5)
        off = Sk - Sq
        qi = torch.arange(Sq)[:, None]
        kj = torch.arange(Sk)[None, :]
        cmask = kj <= (qi + off)
        scores = torch.where(cmask[None, None], scores, -1e9)
        p = _softmax(scores, axis=-1)
        ctx = torch.einsum("bhqk,bhkd->bhqd", p, v)
        return torch.einsum("bhqd,hdm->bqm", ctx, w_o)

    def _B_ref(x, w1, b1, w2, b2):
        h = torch.einsum("bsd,df->bsf", x, w1) + b1
        h = _gelu(h)
        return torch.einsum("bsf,fd->bsd", h, w2) + b2

    x = A_x
    g = _sigmoid((x * gate_w).sum(-1, keepdims=True))
    a = _A_ref(x, A_c_kv, A_w_q, A_w_uk, A_w_uv, A_w_o)
    b = _B_ref(x, B_w1, B_b1, B_w2, B_b2)
    return g * a + (1 - g) * b
```

```asm
; @launch grid=(256,1,1) block=(512,1,1) lds=140288
.amdgcn_target "amdgcn-amd-amdhsa--gfx950"
.text
.globl gated_mix__compressed_kv_cla__dense_activation_gelu__decode_kernel
.p2align 8
.type gated_mix__compressed_kv_cla__dense_activation_gelu__decode_kernel,@function
gated_mix__compressed_kv_cla__dense_activation_gelu__decode_kernel:
    s_load_dwordx8 s[36:43], s[0:1], 0
    s_load_dwordx2 s[48:49], s[0:1], 112
    v_readfirstlane_b32 s3, v0
    v_and_b32 v2, 15, v0
    s_lshr_b32 s35, s2, 5
    s_and_b32 s34, s2, 31
    s_mov_b32 s51, 0x20000
    s_lshr_b32 s52, s2, 8
    s_or_b32 s52, s52, s3
    s_cbranch_scc1 L_rest
    v_lshrrev_b32 v3, 4, v0
    v_lshlrev_b32 v9, 15, v3
    v_lshl_add_u32 v9, v2, 4, v9
    v_add_u32 v10, 7168, v9
    v_add_u32 v11, 14336, v9
    v_add_u32 v12, 21504, v9
    s_mul_i32 s52, s35, 2304
    s_add_u32 s52, s52, s34
    s_lshl_b32 s52, s52, 8
    s_mov_b32 m0, 77824
    v_lshrrev_b32 v13, 3, v2
    v_mul_u32_u24 v13, 144, v13
    v_and_b32 v14, 3, v0
    v_lshl_add_u32 v14, v14, 2, v3
    v_add_lshl_u32 v13, v13, v14, 3
    s_mul_i32 s53, s35, 144
    s_waitcnt lgkmcnt(0)
    s_movk_i32 s38, 2304
    s_mov_b32 s39, s51
    s_add_u32 s42, s52, 581888
    s_mov_b32 s43, s51
    buffer_load_dwordx2 v[186:187], v13, s[36:39], s53 offen
    buffer_load_dwordx2 v[188:189], v13, s[36:39], s53 offen offset:128
L_wq:
    buffer_load_dwordx4 v9, s[40:43], s52 offen nt lds
    buffer_load_dwordx4 v10, s[40:43], s52 offen offset:1024 nt lds
    buffer_load_dwordx4 v11, s[40:43], s52 offen offset:2048 nt lds
    buffer_load_dwordx4 v12, s[40:43], s52 offen offset:3072 nt lds
    s_addk_i32 m0, 4096
    s_add_u32 s52, s52, s51
    s_bitcmp0_b32 m0, 15
    s_cbranch_scc1 L_wq
L_rest:
    s_cmp_ge_u32 s35, 8
    s_cbranch_scc1 L_exit
    s_lshr_b32 s3, s3, 6
    v_and_b32 v1, 63, v0
    v_bfe_u32 v3, v0, 4, 2
    v_lshlrev_b32 v8, 4, v1
    s_getpc_b64 s[64:65]
L_pc:
    s_lshr_b32 s66, s2, 3
    s_lshl_b32 s66, s66, 9
    s_min_u32 s66, s66, L_exit-L_pc-512
    v_add_u32 v249, s66, v8
    s_cmp_eq_u32 s3, 2
    s_cbranch_scc0 L_nopf
    s_mov_b64 exec, 0x01010101
    global_load_dword v250, v249, s[64:65]
    s_mov_b64 exec, -1
L_nopf:
    s_mov_b32 s50, 16777216
    s_lshl_b32 s52, s34, 3
    s_add_u32 s52, s52, s35
    s_lshl_b32 s52, s52, 10
    s_add_u32 s53, s52, 7340032
    s_and_b32 s54, s3, 3
    s_mov_b32 s47, s51
    s_cmp_eq_u32 s3, 3
    s_cselect_b32 exec_lo, 0x01010101, 0
    s_cselect_b32 exec_hi, 0x01010101, 0
    s_waitcnt lgkmcnt(0)
    buffer_load_dword v250, v8, s[48:51], s53 offen sc1
    s_mov_b64 exec, -1
    s_load_dwordx16 s[4:19], s[0:1], 0
    s_load_dwordx8 s[20:27], s[0:1], 64
    s_load_dwordx4 s[28:31], s[0:1], 96
    s_and_b32 s57, s2, 7
    s_bfe_u32 s56, s2, 0x40003
    s_cmp_lt_u32 s3, 4
    s_cbranch_scc1 L_w03
    s_load_dword s58, s[48:49], 0
    s_cmp_ge_u32 s2, 128
    s_cbranch_scc1 L_Ydma
    s_lshl_b32 s64, s35, 2
    s_add_u32 s64, s64, s54
    s_lshl_b32 s64, s64, 10
    s_add_u32 s64, s64, s34
    s_lshl_b32 s64, s64, 8
    s_lshl_b32 m0, s54, 13
    v_xor_b32 v19, v2, v3
    v_lshlrev_b32 v19, 4, v19
    v_lshl_add_u32 v20, v3, 13, v19
    v_xor_b32 v21, 64, v20
    v_xor_b32 v22, 0x80, v20
    v_xor_b32 v23, 0xc0, v20
    v_add_u32 v21, 31744, v21
    v_add_u32 v22, 63488, v22
    v_add_u32 v23, 95232, v23
    s_mov_b64 s[44:45], s[42:43]
    s_mov_b32 s46, 4194304
    s_barrier
    buffer_load_dwordx4 v20, s[44:47], s64 offen offset:0 nt lds
    buffer_load_dwordx4 v21, s[44:47], s64 offen offset:1024 nt lds
    buffer_load_dwordx4 v22, s[44:47], s64 offen offset:2048 nt lds
    buffer_load_dwordx4 v23, s[44:47], s64 offen offset:3072 nt lds
    s_addk_i32 m0, 4096
    s_add_u32 s64, s64, 131072
    buffer_load_dwordx4 v20, s[44:47], s64 offen offset:0 nt lds
    buffer_load_dwordx4 v21, s[44:47], s64 offen offset:1024 nt lds
    buffer_load_dwordx4 v22, s[44:47], s64 offen offset:2048 nt lds
    buffer_load_dwordx4 v23, s[44:47], s64 offen offset:3072 nt lds
    s_branch L_X_w47
L_w03:
    s_load_dword s58, s[48:49], 0
    s_cmp_eq_u32 s3, 0
    s_cbranch_scc1 L_p1c
    s_cmp_ge_u32 s2, 128
    s_cbranch_scc1 L_w13
    s_cmp_lg_u32 s3, 2
    s_cbranch_scc1 L_xb0
L_xb0:
    s_barrier
    s_branch L_w3
L_p1c:
    v_and_b32 v9, 3, v1
    v_lshlrev_b32 v9, 4, v9
    v_mov_b32 v10, 0xffff
    v_mov_b32 v11, 0
    v_lshlrev_b64 v[10:11], v9, v[10:11]
    v_and_b32 v9, 4, v1
    v_cmp_eq_u32 vcc, 0, v9
    s_nop 1
    v_cndmask_b32 v4, 0, v10, vcc
    v_cndmask_b32 v5, 0, v11, vcc
    v_cndmask_b32_e64 v6, v10, 0, vcc
    v_cndmask_b32_e64 v7, v11, 0, vcc
    s_add_u32 s52, s52, 65536
    s_mov_b32 s54, 0x01000100
    s_mov_b32 s55, 0x03020302
    v_add_u32 v190, 77824, v8
    s_waitcnt vmcnt(20)
    s_cmp_ge_u32 s2, 128
    s_cbranch_scc1 L_nob0
    s_barrier
L_nob0:
    v_perm_b32 v12, v186, v186, s54
    v_perm_b32 v13, v186, v186, s55
    v_perm_b32 v14, v187, v187, s54
    v_perm_b32 v15, v187, v187, s55
    v_perm_b32 v16, v188, v188, s54
    v_perm_b32 v17, v188, v188, s55
    v_perm_b32 v18, v189, v189, s54
    v_perm_b32 v19, v189, v189, s55
    v_and_b32_dpp v20, v12, v4 quad_perm:[0,0,0,0] row_mask:0xf bank_mask:0xf
    v_and_b32_dpp v21, v12, v5 quad_perm:[0,0,0,0] row_mask:0xf bank_mask:0xf
    v_and_b32_dpp v22, v12, v6 quad_perm:[0,0,0,0] row_mask:0xf bank_mask:0xf
    v_and_b32_dpp v23, v12, v7 quad_perm:[0,0,0,0] row_mask:0xf bank_mask:0xf
    v_and_b32_dpp v24, v13, v4 quad_perm:[0,0,0,0] row_mask:0xf bank_mask:0xf
    v_and_b32_dpp v25, v13, v5 quad_perm:[0,0,0,0] row_mask:0xf bank_mask:0xf
    v_and_b32_dpp v26, v13, v6 quad_perm:[0,0,0,0] row_mask:0xf bank_mask:0xf
    v_and_b32_dpp v27, v13, v7 quad_perm:[0,0,0,0] row_mask:0xf bank_mask:0xf
    v_and_b32_dpp v28, v14, v4 quad_perm:[0,0,0,0] row_mask:0xf bank_mask:0xf
    v_and_b32_dpp v29, v14, v5 quad_perm:[0,0,0,0] row_mask:0xf bank_mask:0xf
    v_and_b32_dpp v30, v14, v6 quad_perm:[0,0,0,0] row_mask:0xf bank_mask:0xf
    v_and_b32_dpp v31, v14, v7 quad_perm:[0,0,0,0] row_mask:0xf bank_mask:0xf
    v_and_b32_dpp v32, v15, v4 quad_perm:[0,0,0,0] row_mask:0xf bank_mask:0xf
    v_and_b32_dpp v33, v15, v5 quad_perm:[0,0,0,0] row_mask:0xf bank_mask:0xf
    v_and_b32_dpp v34, v15, v6 quad_perm:[0,0,0,0] row_mask:0xf bank_mask:0xf
    v_and_b32_dpp v35, v15, v7 quad_perm:[0,0,0,0] row_mask:0xf bank_mask:0xf
    v_and_b32_dpp v36, v12, v4 quad_perm:[1,1,1,1] row_mask:0xf bank_mask:0xf
    v_and_b32_dpp v37, v12, v5 quad_perm:[1,1,1,1] row_mask:0xf bank_mask:0xf
    v_and_b32_dpp v38, v12, v6 quad_perm:[1,1,1,1] row_mask:0xf bank_mask:0xf
    v_and_b32_dpp v39, v12, v7 quad_perm:[1,1,1,1] row_mask:0xf bank_mask:0xf
    v_and_b32_dpp v40, v13, v4 quad_perm:[1,1,1,1] row_mask:0xf bank_mask:0xf
    v_and_b32_dpp v41, v13, v5 quad_perm:[1,1,1,1] row_mask:0xf bank_mask:0xf
    v_and_b32_dpp v42, v13, v6 quad_perm:[1,1,1,1] row_mask:0xf bank_mask:0xf
    v_and_b32_dpp v43, v13, v7 quad_perm:[1,1,1,1] row_mask:0xf bank_mask:0xf
    v_and_b32_dpp v44, v14, v4 quad_perm:[1,1,1,1] row_mask:0xf bank_mask:0xf
    v_and_b32_dpp v45, v14, v5 quad_perm:[1,1,1,1] row_mask:0xf bank_mask:0xf
    v_and_b32_dpp v46, v14, v6 quad_perm:[1,1,1,1] row_mask:0xf bank_mask:0xf
    v_and_b32_dpp v47, v14, v7 quad_perm:[1,1,1,1] row_mask:0xf bank_mask:0xf
    v_and_b32_dpp v48, v15, v4 quad_perm:[1,1,1,1] row_mask:0xf bank_mask:0xf
    v_and_b32_dpp v49, v15, v5 quad_perm:[1,1,1,1] row_mask:0xf bank_mask:0xf
    v_and_b32_dpp v50, v15, v6 quad_perm:[1,1,1,1] row_mask:0xf bank_mask:0xf
    v_and_b32_dpp v51, v15, v7 quad_perm:[1,1,1,1] row_mask:0xf bank_mask:0xf
    v_and_b32_dpp v52, v12, v4 quad_perm:[2,2,2,2] row_mask:0xf bank_mask:0xf
    v_and_b32_dpp v53, v12, v5 quad_perm:[2,2,2,2] row_mask:0xf bank_mask:0xf
    v_and_b32_dpp v54, v12, v6 quad_perm:[2,2,2,2] row_mask:0xf bank_mask:0xf
    v_and_b32_dpp v55, v12, v7 quad_perm:[2,2,2,2] row_mask:0xf bank_mask:0xf
    v_and_b32_dpp v56, v13, v4 quad_perm:[2,2,2,2] row_mask:0xf bank_mask:0xf
    v_and_b32_dpp v57, v13, v5 quad_perm:[2,2,2,2] row_mask:0xf bank_mask:0xf
    v_and_b32_dpp v58, v13, v6 quad_perm:[2,2,2,2] row_mask:0xf bank_mask:0xf
    v_and_b32_dpp v59, v13, v7 quad_perm:[2,2,2,2] row_mask:0xf bank_mask:0xf
    v_and_b32_dpp v60, v14, v4 quad_perm:[2,2,2,2] row_mask:0xf bank_mask:0xf
    v_and_b32_dpp v61, v14, v5 quad_perm:[2,2,2,2] row_mask:0xf bank_mask:0xf
    v_and_b32_dpp v62, v14, v6 quad_perm:[2,2,2,2] row_mask:0xf bank_mask:0xf
    v_and_b32_dpp v63, v14, v7 quad_perm:[2,2,2,2] row_mask:0xf bank_mask:0xf
    v_and_b32_dpp v64, v15, v4 quad_perm:[2,2,2,2] row_mask:0xf bank_mask:0xf
    v_and_b32_dpp v65, v15, v5 quad_perm:[2,2,2,2] row_mask:0xf bank_mask:0xf
    v_and_b32_dpp v66, v15, v6 quad_perm:[2,2,2,2] row_mask:0xf bank_mask:0xf
    v_and_b32_dpp v67, v15, v7 quad_perm:[2,2,2,2] row_mask:0xf bank_mask:0xf
    v_and_b32_dpp v68, v12, v4 quad_perm:[3,3,3,3] row_mask:0xf bank_mask:0xf
    v_and_b32_dpp v69, v12, v5 quad_perm:[3,3,3,3] row_mask:0xf bank_mask:0xf
    v_and_b32_dpp v70, v12, v6 quad_perm:[3,3,3,3] row_mask:0xf bank_mask:0xf
    v_and_b32_dpp v71, v12, v7 quad_perm:[3,3,3,3] row_mask:0xf bank_mask:0xf
    v_and_b32_dpp v72, v13, v4 quad_perm:[3,3,3,3] row_mask:0xf bank_mask:0xf
    v_and_b32_dpp v73, v13, v5 quad_perm:[3,3,3,3] row_mask:0xf bank_mask:0xf
    v_and_b32_dpp v74, v13, v6 quad_perm:[3,3,3,3] row_mask:0xf bank_mask:0xf
    v_and_b32_dpp v75, v13, v7 quad_perm:[3,3,3,3] row_mask:0xf bank_mask:0xf
    v_and_b32_dpp v76, v14, v4 quad_perm:[3,3,3,3] row_mask:0xf bank_mask:0xf
    v_and_b32_dpp v77, v14, v5 quad_perm:[3,3,3,3] row_mask:0xf bank_mask:0xf
    v_and_b32_dpp v78, v14, v6 quad_perm:[3,3,3,3] row_mask:0xf bank_mask:0xf
    v_and_b32_dpp v79, v14, v7 quad_perm:[3,3,3,3] row_mask:0xf bank_mask:0xf
    v_and_b32_dpp v80, v15, v4 quad_perm:[3,3,3,3] row_mask:0xf bank_mask:0xf
    v_and_b32_dpp v81, v15, v5 quad_perm:[3,3,3,3] row_mask:0xf bank_mask:0xf
    v_and_b32_dpp v82, v15, v6 quad_perm:[3,3,3,3] row_mask:0xf bank_mask:0xf
    v_and_b32_dpp v83, v15, v7 quad_perm:[3,3,3,3] row_mask:0xf bank_mask:0xf
    v_and_b32_dpp v84, v16, v4 quad_perm:[0,0,0,0] row_mask:0xf bank_mask:0xf
    v_and_b32_dpp v85, v16, v5 quad_perm:[0,0,0,0] row_mask:0xf bank_mask:0xf
    v_and_b32_dpp v86, v16, v6 quad_perm:[0,0,0,0] row_mask:0xf bank_mask:0xf
    v_and_b32_dpp v87, v16, v7 quad_perm:[0,0,0,0] row_mask:0xf bank_mask:0xf
    v_and_b32_dpp v88, v17, v4 quad_perm:[0,0,0,0] row_mask:0xf bank_mask:0xf
    v_and_b32_dpp v89, v17, v5 quad_perm:[0,0,0,0] row_mask:0xf bank_mask:0xf
    v_and_b32_dpp v90, v17, v6 quad_perm:[0,0,0,0] row_mask:0xf bank_mask:0xf
    v_and_b32_dpp v91, v17, v7 quad_perm:[0,0,0,0] row_mask:0xf bank_mask:0xf
    v_and_b32_dpp v92, v18, v4 quad_perm:[0,0,0,0] row_mask:0xf bank_mask:0xf
    v_and_b32_dpp v93, v18, v5 quad_perm:[0,0,0,0] row_mask:0xf bank_mask:0xf
    v_and_b32_dpp v94, v18, v6 quad_perm:[0,0,0,0] row_mask:0xf bank_mask:0xf
    v_and_b32_dpp v95, v18, v7 quad_perm:[0,0,0,0] row_mask:0xf bank_mask:0xf
    v_and_b32_dpp v96, v19, v4 quad_perm:[0,0,0,0] row_mask:0xf bank_mask:0xf
    v_and_b32_dpp v97, v19, v5 quad_perm:[0,0,0,0] row_mask:0xf bank_mask:0xf
    v_and_b32_dpp v98, v19, v6 quad_perm:[0,0,0,0] row_mask:0xf bank_mask:0xf
    v_and_b32_dpp v99, v19, v7 quad_perm:[0,0,0,0] row_mask:0xf bank_mask:0xf
    s_waitcnt lgkmcnt(0)
    s_add_u32 s58, s58, 1
    s_addc_u32 s58, s58, 0
    s_add_u32 s59, s58, 37
    s_add_u32 s60, s58, 74
    s_add_u32 s61, s58, 111
    s_waitcnt vmcnt(16)
    ds_read_b128 v[100:103], v190 offset:0
    ds_read_b128 v[104:107], v190 offset:1024
    ds_read_b128 v[108:111], v190 offset:2048
    ds_read_b128 v[112:115], v190 offset:3072
    s_waitcnt vmcnt(12)
    ds_read_b128 v[116:119], v190 offset:4096
    ds_read_b128 v[120:123], v190 offset:5120
    ds_read_b128 v[124:127], v190 offset:6144
    ds_read_b128 v[128:131], v190 offset:7168
    s_waitcnt lgkmcnt(4)
    v_mfma_f32_16x16x32_bf16 v[180:183], v[20:23], v[100:103], 0
    v_mfma_f32_16x16x32_bf16 v[180:183], v[24:27], v[104:107], v[180:183]
    v_mfma_f32_16x16x32_bf16 v[180:183], v[28:31], v[108:111], v[180:183]
    v_mfma_f32_16x16x32_bf16 v[180:183], v[32:35], v[112:115], v[180:183]
    s_waitcnt vmcnt(8)
    ds_read_b128 v[132:135], v190 offset:8192
    ds_read_b128 v[136:139], v190 offset:9216
    ds_read_b128 v[140:143], v190 offset:10240
    ds_read_b128 v[144:147], v190 offset:11264
    s_waitcnt lgkmcnt(4)
    v_mfma_f32_16x16x32_bf16 v[180:183], v[36:39], v[116:119], v[180:183]
    v_mfma_f32_16x16x32_bf16 v[180:183], v[40:43], v[120:123], v[180:183]
    v_mfma_f32_16x16x32_bf16 v[180:183], v[44:47], v[124:127], v[180:183]
    v_mfma_f32_16x16x32_bf16 v[180:183], v[48:51], v[128:131], v[180:183]
    s_waitcnt vmcnt(4)
    ds_read_b128 v[148:151], v190 offset:12288
    ds_read_b128 v[152:155], v190 offset:13312
    ds_read_b128 v[156:159], v190 offset:14336
    ds_read_b128 v[160:163], v190 offset:15360
    s_waitcnt lgkmcnt(4)
    v_mfma_f32_16x16x32_bf16 v[180:183], v[52:55], v[132:135], v[180:183]
    v_mfma_f32_16x16x32_bf16 v[180:183], v[56:59], v[136:139], v[180:183]
    v_mfma_f32_16x16x32_bf16 v[180:183], v[60:63], v[140:143], v[180:183]
    v_mfma_f32_16x16x32_bf16 v[180:183], v[64:67], v[144:147], v[180:183]
    s_waitcnt vmcnt(0)
    ds_read_b128 v[164:167], v190 offset:16384
    ds_read_b128 v[168:171], v190 offset:17408
    ds_read_b128 v[172:175], v190 offset:18432
    ds_read_b128 v[176:179], v190 offset:19456
    s_waitcnt lgkmcnt(4)
    v_mfma_f32_16x16x32_bf16 v[180:183], v[68:71], v[148:151], v[180:183]
    v_mfma_f32_16x16x32_bf16 v[180:183], v[72:75], v[152:155], v[180:183]
    v_mfma_f32_16x16x32_bf16 v[180:183], v[76:79], v[156:159], v[180:183]
    v_mfma_f32_16x16x32_bf16 v[180:183], v[80:83], v[160:163], v[180:183]
    s_waitcnt lgkmcnt(3)
    v_mfma_f32_16x16x32_bf16 v[180:183], v[84:87], v[164:167], v[180:183]
    s_waitcnt lgkmcnt(2)
    v_mfma_f32_16x16x32_bf16 v[180:183], v[88:91], v[168:171], v[180:183]
    s_waitcnt lgkmcnt(1)
    v_mfma_f32_16x16x32_bf16 v[180:183], v[92:95], v[172:175], v[180:183]
    s_waitcnt lgkmcnt(0)
    v_mfma_f32_16x16x32_bf16 v[180:183], v[96:99], v[176:179], v[180:183]
    s_nop 7
    v_mov_b32_sdwa v180, s58 dst_sel:BYTE_0 dst_unused:UNUSED_PRESERVE src0_sel:BYTE_0
    v_mov_b32_sdwa v181, s59 dst_sel:BYTE_0 dst_unused:UNUSED_PRESERVE src0_sel:BYTE_0
    v_mov_b32_sdwa v182, s60 dst_sel:BYTE_0 dst_unused:UNUSED_PRESERVE src0_sel:BYTE_0
    v_mov_b32_sdwa v183, s61 dst_sel:BYTE_0 dst_unused:UNUSED_PRESERVE src0_sel:BYTE_0
    buffer_store_dwordx4 v[180:183], v8, s[48:51], s53 offen
    buffer_store_dwordx4 v[180:183], v8, s[48:51], s52 offen sc1
    s_barrier
    s_cmp_ge_u32 s2, 128
    s_cbranch_scc1 L_Y_main
    s_branch L_X_main
L_Ydma:
    s_bfe_u32 s75, s2, 0x10006
    s_lshl_b32 s75, s75, 4
    s_add_u32 s75, s75, s54
    s_lshl_b32 s75, s75, 8
    s_and_b32 vcc_lo, s2, 63
    s_add_u32 s75, s75, vcc_lo
    s_lshl_b32 s75, s75, 10
    s_lshl_b32 m0, s54, 12
    s_and_b32 vcc_lo, s54, 1
    s_lshl_b32 vcc_lo, vcc_lo, 7
    s_lshr_b32 vcc_hi, s54, 1
    s_lshl_b32 vcc_hi, vcc_hi, 4
    s_or_b32 vcc_lo, vcc_lo, vcc_hi
    v_xor_b32 v244, vcc_lo, v8
    v_xor_b32 v245, 32, v244
    v_xor_b32 v246, 64, v244
    v_xor_b32 v247, 0x60, v244
    v_add_u32 v245, 64512, v245
    v_add_u32 v246, 129024, v246
    v_add_u32 v247, 193536, v247
    s_mov_b64 s[44:45], s[38:39]
    s_mov_b32 s46, 8388608
    s_waitcnt lgkmcnt(0)
    s_add_u32 s58, s58, 1
    s_addc_u32 s58, s58, 0
    s_add_u32 s59, s58, 37
    s_add_u32 s60, s58, 74
    s_add_u32 s61, s58, 111
    s_sub_u32 s55, s2, 128
    s_lshl_b32 s55, s55, 7
    s_add_u32 s55, s55, 7798784
    v_mov_b32 v14, s58
    v_lshlrev_b32 v15, 2, v1
    s_mov_b32 s40, s12
    s_mov_b32 s41, s13
    s_mov_b32 s42, 4194304
    s_mov_b32 s43, 0x20000
    s_sub_u32 s64, s35, 4
    s_lshl_b32 s64, s64, 20
    s_lshl_b32 s65, s54, 15
    s_add_u32 s64, s64, s65
    s_lshl_b32 s65, s34, 8
    s_add_u32 s64, s64, s65
    v_lshlrev_b32 v9, 1, v3
    v_xor_b32 v9, v9, v2
    v_lshlrev_b32 v9, 4, v9
    v_lshl_add_u32 v44, v3, 17, v9
    v_xor_b32 v45, 0x80, v44
    s_lshl_b32 s65, s54, 13
    s_add_u32 s65, s65, 107520
    s_barrier
    s_mov_b32 vcc_hi, m0
    s_add_u32 m0, s65, 0
    s_add_u32 vcc_lo, s64, 0
    buffer_load_dwordx4 v44, s[40:43], vcc_lo offen nt lds
    s_add_u32 m0, s65, 1024
    s_add_u32 vcc_lo, s64, 524288
    buffer_load_dwordx4 v44, s[40:43], vcc_lo offen nt lds
    s_add_u32 m0, s65, 2048
    s_add_u32 vcc_lo, s64, 8192
    buffer_load_dwordx4 v45, s[40:43], vcc_lo offen nt lds
    s_add_u32 m0, s65, 3072
    s_add_u32 vcc_lo, s64, 532480
    buffer_load_dwordx4 v45, s[40:43], vcc_lo offen nt lds
    s_mov_b32 m0, vcc_hi
    s_nop 0
    buffer_load_dwordx4 v244, s[44:47], s75 offen offset:0 nt lds
    buffer_load_dwordx4 v245, s[44:47], s75 offen offset:1024 nt lds
    buffer_load_dwordx4 v246, s[44:47], s75 offen offset:2048 nt lds
    buffer_load_dwordx4 v247, s[44:47], s75 offen offset:3072 nt lds
    s_add_u32 s75, s75, 1048576
    s_add_u32 m0, m0, 16384
    s_nop 0
    buffer_load_dwordx4 v244, s[44:47], s75 offen offset:0 nt lds
    buffer_load_dwordx4 v245, s[44:47], s75 offen offset:1024 nt lds
    buffer_load_dwordx4 v246, s[44:47], s75 offen offset:2048 nt lds
    buffer_load_dwordx4 v247, s[44:47], s75 offen offset:3072 nt lds
    s_add_u32 s75, s75, 1048576
    s_add_u32 m0, m0, 16384
    s_nop 0
    buffer_load_dwordx4 v244, s[44:47], s75 offen offset:0 nt lds
    s_cmp_eq_u32 s3, 4
    s_cselect_b32 exec_lo, -1, 0
    s_mov_b32 exec_hi, 0
    buffer_store_dword v14, v15, s[48:51], s55 offen sc1
    s_mov_b64 exec, -1
    buffer_load_dwordx4 v245, s[44:47], s75 offen offset:1024 nt lds
    buffer_load_dwordx4 v246, s[44:47], s75 offen offset:2048 nt lds
    buffer_load_dwordx4 v247, s[44:47], s75 offen offset:3072 nt lds
    s_add_u32 s75, s75, 1048576
    s_add_u32 m0, m0, 16384
    s_nop 0
    buffer_load_dwordx4 v244, s[44:47], s75 offen offset:0 nt lds
    buffer_load_dwordx4 v245, s[44:47], s75 offen offset:1024 nt lds
    buffer_load_dwordx4 v246, s[44:47], s75 offen offset:2048 nt lds
    buffer_load_dwordx4 v247, s[44:47], s75 offen offset:3072 nt lds
    v_and_b32 v9, 3, v1
    v_lshlrev_b32 v9, 4, v9
    v_mov_b32 v10, 0xffff
    v_mov_b32 v11, 0
    v_lshlrev_b64 v[10:11], v9, v[10:11]
    v_and_b32 v9, 4, v1
    v_cmp_eq_u32 vcc, 0, v9
    s_nop 1
    v_cndmask_b32 v4, 0, v10, vcc
    v_cndmask_b32 v5, 0, v11, vcc
    v_cndmask_b32_e64 v6, v10, 0, vcc
    v_cndmask_b32_e64 v7, v11, 0, vcc
    s_branch L_Y_main
L_w13:
    s_cmp_eq_u32 s3, 1
    s_cbranch_scc1 L_w1
L_w3:
L_w23:
    v_and_b32 v9, 3, v1
    v_lshlrev_b32 v9, 4, v9
    v_mov_b32 v10, 0xffff
    v_mov_b32 v11, 0
    v_lshlrev_b64 v[10:11], v9, v[10:11]
    v_and_b32 v9, 4, v1
    v_cmp_eq_u32 vcc, 0, v9
    s_nop 1
    v_cndmask_b32 v4, 0, v10, vcc
    v_cndmask_b32 v5, 0, v11, vcc
    v_cndmask_b32_e64 v6, v10, 0, vcc
    v_cndmask_b32_e64 v7, v11, 0, vcc
    s_waitcnt lgkmcnt(0)
    s_add_u32 s58, s58, 1
    s_addc_u32 s58, s58, 0
    s_add_u32 s59, s58, 37
    s_add_u32 s60, s58, 74
    s_add_u32 s61, s58, 111
    s_barrier
    s_waitcnt vmcnt(0)
    s_cmp_ge_u32 s2, 128
    s_cbranch_scc1 L_Y_main
    s_branch L_X_main
L_w1:
    s_movk_i32 s38, 2304
    s_mov_b32 s39, s51
    v_and_b32 v9, 31, v1
    v_mul_u32_u24 v9, 36, v9
    v_lshrrev_b32 v12, 5, v1
    v_mul_u32_u24 v11, 1152, v12
    v_add_u32 v11, v11, v9
    buffer_load_dwordx4 v[20:23], v11, s[36:39], 0 offen
    buffer_load_dwordx4 v[24:27], v11, s[36:39], 0 offen offset:16
    buffer_load_dword v28, v11, s[36:39], 0 offen offset:32
    s_waitcnt lgkmcnt(0)
    s_mov_b32 s40, s26
    s_mov_b32 s41, s27
    s_mov_b32 s42, 1152
    s_mov_b32 s43, 0x20000
    buffer_load_dwordx4 v[32:35], v9, s[40:43], 0 offen
    buffer_load_dwordx4 v[36:39], v9, s[40:43], 0 offen offset:16
    buffer_load_dword v40, v9, s[40:43], 0 offen offset:32
    v_and_b32 v9, 3, v1
    v_lshlrev_b32 v9, 4, v9
    v_mov_b32 v10, 0xffff
    v_mov_b32 v11, 0
    v_lshlrev_b64 v[10:11], v9, v[10:11]
    v_and_b32 v9, 4, v1
    v_cmp_eq_u32 vcc, 0, v9
    s_nop 1
    v_cndmask_b32 v4, 0, v10, vcc
    v_cndmask_b32 v5, 0, v11, vcc
    v_cndmask_b32_e64 v6, v10, 0, vcc
    v_cndmask_b32_e64 v7, v11, 0, vcc
    s_waitcnt lgkmcnt(0)
    s_add_u32 s58, s58, 1
    s_addc_u32 s58, s58, 0
    s_add_u32 s59, s58, 37
    s_add_u32 s60, s58, 74
    s_add_u32 s61, s58, 111
    v_mov_b32 v13, 0
    v_lshlrev_b32 v10, 2, v12
    v_add_u32 v10, 107008, v10
    s_barrier
    s_waitcnt vmcnt(0)
    v_dot2_f32_bf16 v13, v20, v32, v13
    v_dot2_f32_bf16 v13, v21, v33, v13
    v_dot2_f32_bf16 v13, v22, v34, v13
    v_dot2_f32_bf16 v13, v23, v35, v13
    v_dot2_f32_bf16 v13, v24, v36, v13
    v_dot2_f32_bf16 v13, v25, v37, v13
    v_dot2_f32_bf16 v13, v26, v38, v13
    v_dot2_f32_bf16 v13, v27, v39, v13
    v_dot2_f32_bf16 v13, v28, v40, v13
    s_nop 2
    v_add_f32_dpp v13, v13, v13 quad_perm:[1,0,3,2] row_mask:0xf bank_mask:0xf
    s_nop 1
    v_add_f32_dpp v13, v13, v13 quad_perm:[2,3,0,1] row_mask:0xf bank_mask:0xf
    s_nop 1
    v_add_f32_dpp v13, v13, v13 row_half_mirror row_mask:0xf bank_mask:0xf
    s_nop 1
    v_add_f32_dpp v13, v13, v13 row_mirror row_mask:0xf bank_mask:0xf
    v_mov_b32 v14, v13
    s_nop 1
    v_permlane16_swap_b32 v13, v14
    v_add_f32 v13, v13, v14
    v_mul_f32 v13, 3216550459, v13
    v_exp_f32 v13, v13
    s_nop 0
    v_add_f32 v13, 1.0, v13
    v_rcp_f32 v13, v13
    s_nop 0
    ds_write_b32 v10, v13
    s_waitcnt lgkmcnt(0)
    s_branch L_Y_main
L_X_w47:
    v_and_b32 v9, 3, v1
    v_lshlrev_b32 v9, 4, v9
    v_mov_b32 v10, 0xffff
    v_mov_b32 v11, 0
    v_lshlrev_b64 v[10:11], v9, v[10:11]
    v_and_b32 v9, 4, v1
    v_cmp_eq_u32 vcc, 0, v9
    s_nop 1
    v_cndmask_b32 v4, 0, v10, vcc
    v_cndmask_b32 v5, 0, v11, vcc
    v_cndmask_b32_e64 v6, v10, 0, vcc
    v_cndmask_b32_e64 v7, v11, 0, vcc
    v_mov_b32 v9, v19
    s_waitcnt lgkmcnt(0)
    s_add_u32 s58, s58, 1
    s_addc_u32 s58, s58, 0
    s_add_u32 s59, s58, 37
    s_add_u32 s60, s58, 74
    s_add_u32 s61, s58, 111
    s_lshl_b32 s52, s34, 13
    s_lshl_b32 s53, s54, 8
    s_add_u32 s52, s52, s53
    s_add_u32 s52, s52, 7340032
    s_add_u32 s53, s52, 4096
    v_lshlrev_b32 v24, 10, v3
    v_lshl_add_u32 v24, v2, 4, v24
    s_lshr_b32 s55, s54, 1
    s_lshl_b32 s55, s55, 8
    s_bitcmp1_b32 s54, 0
    s_cselect_b32 vcc_lo, 8, 0
    s_add_u32 s55, s55, vcc_lo
    s_add_u32 s55, s55, 65536
    v_lshlrev_b32 v25, 4, v2
    v_lshl_add_u32 v25, v3, 1, v25
    v_add_u32 v25, s55, v25
    s_lshl_b32 s55, s54, 13
    v_lshl_add_u32 v26, v2, 8, v9
    v_add_u32 v26, s55, v26
    v_xor_b32 v27, 64, v26
    v_xor_b32 v28, 0x80, v26
    v_xor_b32 v29, 0xc0, v26
    v_lshrrev_b32 v30, 3, v2
    v_lshlrev_b32 v30, 8, v30
    v_lshl_add_u32 v30, v3, 4, v30
    v_add_u32 v30, 65536, v30
    v_and_b32 v31, 31, v1
    s_lshl_b32 s55, s54, 5
    v_add_u32 v31, s55, v31
    v_bfe_u32 v32, v31, 3, 3
    v_mul_u32_u24 v32, 37, v32
    v_add_u32 v32, s58, v32
    v_and_b32 v33, 7, v31
    v_lshrrev_b32 v32, v33, v32
    v_and_b32 v32, 1, v32
    v_lshlrev_b32 v32, 16, v32
    v_xor_b32 v33, 0x10000, v32
    v_lshlrev_b32 v31, 1, v31
    v_lshrrev_b32 v34, 5, v1
    v_lshl_add_u32 v31, v34, 15, v31
    s_lshl_b32 s55, s34, 10
    s_lshl_b32 vcc_lo, s35, 8
    s_add_u32 s55, s55, vcc_lo
    s_add_u32 s55, s55, 327680
    v_mov_b32 v35, 0xfffe0000
    s_lshr_b32 s66, s34, 2
    s_mul_i32 s66, s66, 2304
    s_and_b32 vcc_lo, s34, 3
    s_lshl_b32 vcc_lo, vcc_lo, 2
    s_add_u32 vcc_lo, vcc_lo, s35
    s_lshl_b32 vcc_lo, vcc_lo, 2
    s_add_u32 s66, s66, vcc_lo
    s_add_u32 s66, s66, 8454144
    v_mul_u32_u24 v104, 18432, v1
    v_mov_b32 v105, s58
    s_barrier
    s_waitcnt vmcnt(2)
    s_mov_b32 s62, 0
poll_1:
    buffer_load_dwordx4 v[36:39], v24, s[48:51], s52 offen sc1
    buffer_load_dwordx4 v[40:43], v24, s[48:51], s53 offen sc1
    s_waitcnt vmcnt(1)
    v_xor_b32 v44, s58, v36
    v_bitop3_b32 v44, v44, v37, s59 bitop3:0xf6
    v_bitop3_b32 v44, v44, v38, s60 bitop3:0xf6
    v_bitop3_b32 v44, v44, v39, s61 bitop3:0xf6
    s_waitcnt vmcnt(0)
    v_bitop3_b32 v44, v44, v40, s58 bitop3:0xf6
    v_bitop3_b32 v44, v44, v41, s59 bitop3:0xf6
    v_bitop3_b32 v44, v44, v42, s60 bitop3:0xf6
    v_bitop3_b32 v44, v44, v43, s61 bitop3:0xf6
    v_and_b32 v44, 0xff, v44
    v_cmp_ne_u32 vcc, 0, v44
    s_add_u32 s62, s62, 1
    s_cbranch_vccz done_2
    s_cmp_eq_u32 s62, 256
    s_cselect_b32 vcc_lo, 7274496, 0
    s_sub_u32 s52, s52, vcc_lo
    s_sub_u32 s53, s53, vcc_lo
    s_cmp_lt_u32 s62, 200000
    s_cbranch_scc1 poll_1
done_2:
    ds_read_b128 v[48:51], v26 offset:0
    ds_read_b128 v[52:55], v27 offset:0
    ds_read_b128 v[56:59], v28 offset:0
    ds_read_b128 v[60:63], v29 offset:0
    ds_read_b128 v[64:67], v26 offset:4096
    ds_read_b128 v[68:71], v27 offset:4096
    ds_read_b128 v[72:75], v28 offset:4096
    ds_read_b128 v[76:79], v29 offset:4096
    v_add_f32 v36, v36, v40
    v_add_f32 v37, v37, v41
    v_add_f32 v38, v38, v42
    v_add_f32 v39, v39, v43
    s_nop 0
    v_permlane32_swap_b32 v36, v38
    v_permlane32_swap_b32 v37, v39
    v_add_f32 v36, v36, v38
    v_add_f32 v37, v37, v39
    s_nop 1
    v_permlane16_swap_b32 v36, v37
    v_add_f32 v36, v36, v37
    v_cvt_pk_bf16_f32 v36, v36, v36
    ds_write_b16 v25, v36
    s_waitcnt lgkmcnt(0)
    s_barrier
    ds_read_b128 v[80:83], v30 offset:0
    ds_read_b128 v[84:87], v30 offset:64
    ds_read_b128 v[88:91], v30 offset:128
    ds_read_b128 v[92:95], v30 offset:192
    s_waitcnt lgkmcnt(3)
    v_mfma_f32_16x16x32_bf16 v[96:99], v[80:83], v[48:51], 0
    v_mfma_f32_16x16x32_bf16 v[100:103], v[80:83], v[64:67], 0
    s_waitcnt lgkmcnt(2)
    v_mfma_f32_16x16x32_bf16 v[96:99], v[84:87], v[52:55], v[96:99]
    v_mfma_f32_16x16x32_bf16 v[100:103], v[84:87], v[68:71], v[100:103]
    s_waitcnt lgkmcnt(1)
    v_mfma_f32_16x16x32_bf16 v[96:99], v[88:91], v[56:59], v[96:99]
    v_mfma_f32_16x16x32_bf16 v[100:103], v[88:91], v[72:75], v[100:103]
    s_waitcnt lgkmcnt(0)
    v_mfma_f32_16x16x32_bf16 v[96:99], v[92:95], v[60:63], v[96:99]
    v_mfma_f32_16x16x32_bf16 v[100:103], v[92:95], v[76:79], v[100:103]
    s_mov_b32 vcc_lo, 0xffff0000
    s_mov_b32 vcc_hi, 0xffff0000
    s_nop 5
    v_cndmask_b32 v96, v96, v100, vcc
    v_mul_f32 v96, 1040356334, v96
    v_add_u32 v96, v96, v33
    v_and_or_b32 v96, v96, v35, v32
    buffer_store_short_d16_hi v96, v31, s[48:51], s55 offen sc1
L_X_main:
    s_mul_i32 s52, s56, 9
    v_add_u32 v9, s52, v2
    v_lshrrev_b32 v139, 5, v9
    v_lshlrev_b32 v139, 7, v139
    v_and_b32 v10, 15, v9
    v_lshl_add_u32 v139, v10, 3, v139
    v_bfe_u32 v10, v9, 4, 1
    v_lshl_add_u32 v139, v10, 2, v139
    v_and_b32 v10, 7, v9
    v_lshlrev_b32 v10, 3, v10
    v_bfe_u32 v11, v9, 3, 1
    v_lshl_add_u32 v10, v11, 2, v10
    v_add_u32 v10, 512, v10
    v_cmp_gt_u32 vcc, 128, v9
    s_nop 1
    v_cndmask_b32 v139, v10, v139, vcc
    s_mul_i32 s52, s57, 576
    v_add_u32 v139, s52, v139
    v_mul_u32_u24 v10, 1152, v139
    s_nop 0
    v_readlane_b32 s64, v10, 0
    v_readlane_b32 s65, v10, 1
    v_readlane_b32 s66, v10, 2
    v_readlane_b32 s67, v10, 3
    v_readlane_b32 s68, v10, 4
    v_readlane_b32 s69, v10, 5
    v_readlane_b32 s70, v10, 6
    v_readlane_b32 s71, v10, 7
    v_readlane_b32 s72, v10, 8
    v_bfe_u32 v9, v1, 3, 1
    v_lshlrev_b32 v135, 2, v1
    v_lshlrev_b32 v136, 2, v9
    v_add_u32 v136, 107008, v136
    v_mov_b32 v137, s58
    v_mov_b32 v138, 0
    v_mov_b32 v133, 0
    v_and_b32 v132, 3, v1
    v_lshl_add_u32 v134, v132, 2, v3
    v_lshlrev_b32 v134, 2, v134
    v_mul_u32_u24 v9, 192, v9
    v_add_u32 v134, v134, v9
    v_add_u32 v134, 106496, v134
    v_mul_u32_u24 v132, 37, v132
    v_add_u32 v132, s58, v132
    s_lshl_b32 s73, s34, 2
    s_add_u32 s73, s73, s35
    s_mul_i32 s75, s73, 36864
    s_lshl_b32 s73, s73, 10
    s_add_u32 s73, s73, 7602176
    s_mul_i32 s74, s2, 4608
    s_add_u32 s74, s74, 1179648
    s_mov_b32 s36, s4
    s_mov_b32 s37, s5
    s_mov_b32 s38, 2304
    s_mov_b32 s39, 0x20000
    v_bfe_u32 v12, v1, 3, 1
    v_mul_u32_u24 v12, 1152, v12
    v_and_b32 v9, 3, v1
    v_lshl_add_u32 v12, v9, 3, v12
    v_lshl_add_u32 v12, v3, 1, v12
    s_cmp_ge_u32 s3, 4
    s_cbranch_scc1 L_X_b2
    s_barrier
    s_cmp_lg_u32 s3, 0
    s_cbranch_scc1 L_X_b2
    s_lshl_b32 s54, s2, 7
    s_add_u32 s54, s54, 7798784
    s_xor_b32 s55, s54, 5504
    s_mov_b32 s62, 0
sp_3:
    s_load_dword s52, s[48:49], s54 glc
    s_load_dword s53, s[48:49], s55 glc
    s_add_u32 s62, s62, 1
    s_waitcnt lgkmcnt(0)
    s_cmp_eq_u32 s52, s58
    s_cbranch_scc1 spd_4
    s_cmp_eq_u32 s53, s58
    s_cbranch_scc1 spd_4
    s_cmp_lt_u32 s62, 200000
    s_cbranch_scc1 sp_3
spd_4:
L_X_b2:
    s_barrier
    s_cmp_ge_u32 s3, 5
    s_cbranch_scc1 L_X_fg
    s_mov_b32 s40, s18
    s_mov_b32 s41, s19
    s_mov_b32 s42, 5308416
    s_mov_b32 s43, 0x20000
    s_mul_i32 s53, s56, 72
    buffer_load_ushort v13, v12, s[36:39], s53 offen offset:0
    buffer_load_ushort v14, v12, s[36:39], s53 offen offset:32
    buffer_load_ushort v15, v12, s[36:39], s53 offen offset:64
    s_mov_b32 s36, s22
    s_mov_b32 s37, s23
    s_mov_b32 s38, 5308416
    s_mov_b32 s39, 0x20000
    s_mov_b32 s44, s14
    s_mov_b32 s45, s15
    s_mov_b32 s46, 4718592
    s_mov_b32 s47, 0x20000
    s_mul_i32 s52, s56, 331776
    s_mul_i32 s53, s57, 1152
    s_add_u32 s52, s52, s53
    s_lshl_b32 s53, s3, 8
    s_add_u32 s52, s52, s53
    v_mul_u32_u24 v10, 9216, v3
    v_mul_u32_u24 v17, 1152, v3
    v_add_u32 v17, s53, v17
    v_add_u32 v16, s53, v10
    s_lshl_b32 s54, s57, 4
    s_add_u32 s54, s54, s56
    s_mul_i32 s54, s54, 4608
    s_add_u32 s54, s54, 589824
    s_cmp_eq_u32 s3, 4
    s_cbranch_scc1 L_X_f1half
    v_lshl_add_u32 v10, v2, 4, v10
    v_lshl_add_u32 v16, v2, 4, v16
    v_lshl_add_u32 v17, v2, 4, v17
    buffer_load_dwordx4 v[60:63], v10, s[40:43], s52 offen nt
    s_add_u32 s52, s52, 36864
    buffer_load_dwordx4 v[64:67], v10, s[40:43], s52 offen nt
    s_add_u32 s52, s52, 36864
    buffer_load_dwordx4 v[68:71], v10, s[40:43], s52 offen nt
    s_add_u32 s52, s52, 36864
    buffer_load_dwordx4 v[72:75], v10, s[40:43], s52 offen nt
    s_add_u32 s52, s52, 36864
    buffer_load_dwordx4 v[76:79], v10, s[40:43], s52 offen nt
    s_add_u32 s52, s52, 36864
    buffer_load_dwordx4 v[80:83], v10, s[40:43], s52 offen nt
    s_add_u32 s52, s52, 36864
    buffer_load_dwordx4 v[84:87], v10, s[40:43], s52 offen nt
    s_add_u32 s52, s52, 36864
    buffer_load_dwordx4 v[88:91], v10, s[40:43], s52 offen nt
    s_add_u32 s52, s52, 36864
    buffer_load_dwordx4 v[92:95], v10, s[40:43], s52 offen nt
    v_lshrrev_b32 v138, 1, v3
    v_mul_u32_u24 v138, 2304, v138
    v_lshl_add_u32 v138, v2, 4, v138
    v_and_b32 v9, 1, v3
    v_lshl_add_u32 v138, v9, 8, v138
    s_lshl_b32 s52, s3, 9
    v_add_u32 v138, s52, v138
    s_waitcnt vmcnt(9)
    v_lshl_or_b32 v13, v13, 16, v13
    v_lshl_or_b32 v14, v14, 16, v14
    v_lshl_or_b32 v15, v15, 16, v15
    v_and_b32_dpp v20, v13, v4 quad_perm:[0,0,0,0] row_mask:0xf bank_mask:0xf
    v_and_b32_dpp v21, v13, v5 quad_perm:[0,0,0,0] row_mask:0xf bank_mask:0xf
    v_and_b32_dpp v22, v13, v6 quad_perm:[0,0,0,0] row_mask:0xf bank_mask:0xf
    v_and_b32_dpp v23, v13, v7 quad_perm:[0,0,0,0] row_mask:0xf bank_mask:0xf
    v_and_b32_dpp v24, v13, v4 quad_perm:[1,1,1,1] row_mask:0xf bank_mask:0xf
    v_and_b32_dpp v25, v13, v5 quad_perm:[1,1,1,1] row_mask:0xf bank_mask:0xf
    v_and_b32_dpp v26, v13, v6 quad_perm:[1,1,1,1] row_mask:0xf bank_mask:0xf
    v_and_b32_dpp v27, v13, v7 quad_perm:[1,1,1,1] row_mask:0xf bank_mask:0xf
    v_and_b32_dpp v28, v13, v4 quad_perm:[2,2,2,2] row_mask:0xf bank_mask:0xf
    v_and_b32_dpp v29, v13, v5 quad_perm:[2,2,2,2] row_mask:0xf bank_mask:0xf
    v_and_b32_dpp v30, v13, v6 quad_perm:[2,2,2,2] row_mask:0xf bank_mask:0xf
    v_and_b32_dpp v31, v13, v7 quad_perm:[2,2,2,2] row_mask:0xf bank_mask:0xf
    v_and_b32_dpp v32, v13, v4 quad_perm:[3,3,3,3] row_mask:0xf bank_mask:0xf
    v_and_b32_dpp v33, v13, v5 quad_perm:[3,3,3,3] row_mask:0xf bank_mask:0xf
    v_and_b32_dpp v34, v13, v6 quad_perm:[3,3,3,3] row_mask:0xf bank_mask:0xf
    v_and_b32_dpp v35, v13, v7 quad_perm:[3,3,3,3] row_mask:0xf bank_mask:0xf
    v_and_b32_dpp v36, v14, v4 quad_perm:[0,0,0,0] row_mask:0xf bank_mask:0xf
    v_and_b32_dpp v37, v14, v5 quad_perm:[0,0,0,0] row_mask:0xf bank_mask:0xf
    v_and_b32_dpp v38, v14, v6 quad_perm:[0,0,0,0] row_mask:0xf bank_mask:0xf
    v_and_b32_dpp v39, v14, v7 quad_perm:[0,0,0,0] row_mask:0xf bank_mask:0xf
    v_and_b32_dpp v40, v14, v4 quad_perm:[1,1,1,1] row_mask:0xf bank_mask:0xf
    v_and_b32_dpp v41, v14, v5 quad_perm:[1,1,1,1] row_mask:0xf bank_mask:0xf
    v_and_b32_dpp v42, v14, v6 quad_perm:[1,1,1,1] row_mask:0xf bank_mask:0xf
    v_and_b32_dpp v43, v14, v7 quad_perm:[1,1,1,1] row_mask:0xf bank_mask:0xf
    v_and_b32_dpp v44, v14, v4 quad_perm:[2,2,2,2] row_mask:0xf bank_mask:0xf
    v_and_b32_dpp v45, v14, v5 quad_perm:[2,2,2,2] row_mask:0xf bank_mask:0xf
    v_and_b32_dpp v46, v14, v6 quad_perm:[2,2,2,2] row_mask:0xf bank_mask:0xf
    v_and_b32_dpp v47, v14, v7 quad_perm:[2,2,2,2] row_mask:0xf bank_mask:0xf
    v_and_b32_dpp v48, v14, v4 quad_perm:[3,3,3,3] row_mask:0xf bank_mask:0xf
    v_and_b32_dpp v49, v14, v5 quad_perm:[3,3,3,3] row_mask:0xf bank_mask:0xf
    v_and_b32_dpp v50, v14, v6 quad_perm:[3,3,3,3] row_mask:0xf bank_mask:0xf
    v_and_b32_dpp v51, v14, v7 quad_perm:[3,3,3,3] row_mask:0xf bank_mask:0xf
    v_and_b32_dpp v52, v15, v4 quad_perm:[0,0,0,0] row_mask:0xf bank_mask:0xf
    v_and_b32_dpp v53, v15, v5 quad_perm:[0,0,0,0] row_mask:0xf bank_mask:0xf
    v_and_b32_dpp v54, v15, v6 quad_perm:[0,0,0,0] row_mask:0xf bank_mask:0xf
    v_and_b32_dpp v55, v15, v7 quad_perm:[0,0,0,0] row_mask:0xf bank_mask:0xf
    s_waitcnt vmcnt(8)
    v_mfma_f32_16x16x32_bf16 v[100:103], v[20:23], v[60:63], 0
    buffer_load_dwordx4 v[176:179], v17, s[36:39], s64 offen nt
    s_waitcnt vmcnt(8)
    v_mfma_f32_16x16x32_bf16 v[100:103], v[24:27], v[64:67], v[100:103]
    buffer_load_dwordx4 v[180:183], v17, s[36:39], s65 offen nt
    s_waitcnt vmcnt(8)
    v_mfma_f32_16x16x32_bf16 v[100:103], v[28:31], v[68:71], v[100:103]
    buffer_load_dwordx4 v[184:187], v17, s[36:39], s66 offen nt
    s_waitcnt vmcnt(8)
    v_mfma_f32_16x16x32_bf16 v[100:103], v[32:35], v[72:75], v[100:103]
    buffer_load_dwordx4 v[188:191], v17, s[36:39], s67 offen nt
    s_waitcnt vmcnt(8)
    v_mfma_f32_16x16x32_bf16 v[100:103], v[36:39], v[76:79], v[100:103]
    buffer_load_dwordx4 v[192:195], v17, s[36:39], s68 offen nt
    s_waitcnt vmcnt(8)
    v_mfma_f32_16x16x32_bf16 v[100:103], v[40:43], v[80:83], v[100:103]
    buffer_load_dwordx4 v[196:199], v17, s[36:39], s69 offen nt
    s_waitcnt vmcnt(8)
    v_mfma_f32_16x16x32_bf16 v[100:103], v[44:47], v[84:87], v[100:103]
    buffer_load_dwordx4 v[200:203], v17, s[36:39], s70 offen nt
    s_waitcnt vmcnt(8)
    v_mfma_f32_16x16x32_bf16 v[100:103], v[48:51], v[88:91], v[100:103]
    buffer_load_dwordx4 v[204:207], v17, s[36:39], s71 offen nt
    s_waitcnt vmcnt(8)
    v_mfma_f32_16x16x32_bf16 v[100:103], v[52:55], v[92:95], v[100:103]
    s_nop 7
    v_mov_b32_sdwa v100, s58 dst_sel:BYTE_0 dst_unused:UNUSED_PRESERVE src0_sel:BYTE_0
    v_mov_b32_sdwa v101, s59 dst_sel:BYTE_0 dst_unused:UNUSED_PRESERVE src0_sel:BYTE_0
    v_mov_b32_sdwa v102, s60 dst_sel:BYTE_0 dst_unused:UNUSED_PRESERVE src0_sel:BYTE_0
    v_mov_b32_sdwa v103, s61 dst_sel:BYTE_0 dst_unused:UNUSED_PRESERVE src0_sel:BYTE_0
    s_add_u32 vcc_lo, s54, 5767168
    buffer_store_dwordx4 v[100:103], v138, s[48:51], vcc_lo offen
    buffer_store_dwordx4 v[100:103], v138, s[48:51], s54 offen sc1
    buffer_load_dwordx4 v[208:211], v17, s[36:39], s72 offen nt
    s_barrier
    buffer_load_dwordx4 v[140:143], v16, s[44:47], s75 offen offset:0 nt
    buffer_load_dwordx4 v[144:147], v16, s[44:47], s75 offen offset:1152 nt
    buffer_load_dwordx4 v[148:151], v16, s[44:47], s75 offen offset:2304 nt
    buffer_load_dwordx4 v[152:155], v16, s[44:47], s75 offen offset:3456 nt
    s_add_u32 s75, s75, 4608
    s_barrier
    s_barrier
    buffer_load_dwordx4 v[156:159], v16, s[44:47], s75 offen offset:0 nt
    buffer_load_dwordx4 v[160:163], v16, s[44:47], s75 offen offset:1152 nt
    buffer_load_dwordx4 v[164:167], v16, s[44:47], s75 offen offset:2304 nt
    buffer_load_dwordx4 v[168:171], v16, s[44:47], s75 offen offset:3456 nt
    s_branch L_X_o2
L_X_f1half:
    v_and_b32 v9, 7, v2
    v_lshl_add_u32 v10, v9, 4, v10
    v_lshl_add_u32 v16, v9, 4, v16
    v_lshl_add_u32 v17, v9, 4, v17
    v_lshrrev_b32 v9, 3, v2
    v_mul_u32_u24 v11, 36864, v9
    v_add_u32 v10, v10, v11
    v_mul_u32_u24 v11, 1152, v9
    v_add_u32 v16, v16, v11
    buffer_load_dwordx4 v[60:63], v10, s[40:43], s52 offen nt
    s_add_u32 s52, s52, 73728
    buffer_load_dwordx4 v[64:67], v10, s[40:43], s52 offen nt
    s_add_u32 s52, s52, 73728
    buffer_load_dwordx4 v[68:71], v10, s[40:43], s52 offen nt
    s_add_u32 s52, s52, 73728
    buffer_load_dwordx4 v[72:75], v10, s[40:43], s52 offen nt
    s_add_u32 s52, s52, 73728
    s_mov_b32 exec_lo, 0x00ff00ff
    s_mov_b32 exec_hi, 0x00ff00ff
    buffer_load_dwordx4 v[76:79], v10, s[40:43], s52 offen nt
    s_mov_b64 exec, -1
    v_lshrrev_b32 v138, 1, v3
    v_mul_u32_u24 v138, 2304, v138
    v_lshl_add_u32 v138, v2, 4, v138
    v_and_b32 v9, 1, v3
    v_lshl_add_u32 v138, v9, 7, v138
    v_add_u32 v138, 2048, v138
    s_waitcnt vmcnt(5)
    v_lshl_or_b32 v13, v13, 16, v13
    v_lshl_or_b32 v14, v14, 16, v14
    v_lshl_or_b32 v15, v15, 16, v15
    v_and_b32_dpp v20, v13, v4 quad_perm:[0,0,0,0] row_mask:0xf bank_mask:0xf
    v_and_b32_dpp v21, v13, v5 quad_perm:[0,0,0,0] row_mask:0xf bank_mask:0xf
    v_and_b32_dpp v22, v13, v6 quad_perm:[0,0,0,0] row_mask:0xf bank_mask:0xf
    v_and_b32_dpp v23, v13, v7 quad_perm:[0,0,0,0] row_mask:0xf bank_mask:0xf
    v_and_b32_dpp v24, v13, v4 quad_perm:[1,1,1,1] row_mask:0xf bank_mask:0xf
    v_and_b32_dpp v25, v13, v5 quad_perm:[1,1,1,1] row_mask:0xf bank_mask:0xf
    v_and_b32_dpp v26, v13, v6 quad_perm:[1,1,1,1] row_mask:0xf bank_mask:0xf
    v_and_b32_dpp v27, v13, v7 quad_perm:[1,1,1,1] row_mask:0xf bank_mask:0xf
    v_and_b32_dpp v28, v13, v4 quad_perm:[2,2,2,2] row_mask:0xf bank_mask:0xf
    v_and_b32_dpp v29, v13, v5 quad_perm:[2,2,2,2] row_mask:0xf bank_mask:0xf
    v_and_b32_dpp v30, v13, v6 quad_perm:[2,2,2,2] row_mask:0xf bank_mask:0xf
    v_and_b32_dpp v31, v13, v7 quad_perm:[2,2,2,2] row_mask:0xf bank_mask:0xf
    v_and_b32_dpp v32, v13, v4 quad_perm:[3,3,3,3] row_mask:0xf bank_mask:0xf
    v_and_b32_dpp v33, v13, v5 quad_perm:[3,3,3,3] row_mask:0xf bank_mask:0xf
    v_and_b32_dpp v34, v13, v6 quad_perm:[3,3,3,3] row_mask:0xf bank_mask:0xf
    v_and_b32_dpp v35, v13, v7 quad_perm:[3,3,3,3] row_mask:0xf bank_mask:0xf
    v_and_b32_dpp v36, v14, v4 quad_perm:[0,0,0,0] row_mask:0xf bank_mask:0xf
    v_and_b32_dpp v37, v14, v5 quad_perm:[0,0,0,0] row_mask:0xf bank_mask:0xf
    v_and_b32_dpp v38, v14, v6 quad_perm:[0,0,0,0] row_mask:0xf bank_mask:0xf
    v_and_b32_dpp v39, v14, v7 quad_perm:[0,0,0,0] row_mask:0xf bank_mask:0xf
    v_and_b32_dpp v40, v14, v4 quad_perm:[1,1,1,1] row_mask:0xf bank_mask:0xf
    v_and_b32_dpp v41, v14, v5 quad_perm:[1,1,1,1] row_mask:0xf bank_mask:0xf
    v_and_b32_dpp v42, v14, v6 quad_perm:[1,1,1,1] row_mask:0xf bank_mask:0xf
    v_and_b32_dpp v43, v14, v7 quad_perm:[1,1,1,1] row_mask:0xf bank_mask:0xf
    v_and_b32_dpp v44, v14, v4 quad_perm:[2,2,2,2] row_mask:0xf bank_mask:0xf
    v_and_b32_dpp v45, v14, v5 quad_perm:[2,2,2,2] row_mask:0xf bank_mask:0xf
    v_and_b32_dpp v46, v14, v6 quad_perm:[2,2,2,2] row_mask:0xf bank_mask:0xf
    v_and_b32_dpp v47, v14, v7 quad_perm:[2,2,2,2] row_mask:0xf bank_mask:0xf
    v_and_b32_dpp v48, v14, v4 quad_perm:[3,3,3,3] row_mask:0xf bank_mask:0xf
    v_and_b32_dpp v49, v14, v5 quad_perm:[3,3,3,3] row_mask:0xf bank_mask:0xf
    v_and_b32_dpp v50, v14, v6 quad_perm:[3,3,3,3] row_mask:0xf bank_mask:0xf
    v_and_b32_dpp v51, v14, v7 quad_perm:[3,3,3,3] row_mask:0xf bank_mask:0xf
    v_and_b32_dpp v52, v15, v4 quad_perm:[0,0,0,0] row_mask:0xf bank_mask:0xf
    v_and_b32_dpp v53, v15, v5 quad_perm:[0,0,0,0] row_mask:0xf bank_mask:0xf
    v_and_b32_dpp v54, v15, v6 quad_perm:[0,0,0,0] row_mask:0xf bank_mask:0xf
    v_and_b32_dpp v55, v15, v7 quad_perm:[0,0,0,0] row_mask:0xf bank_mask:0xf
    s_waitcnt vmcnt(4)
    v_mfma_f32_16x16x32_bf16 v[100:103], v[20:23], v[60:63], 0
    v_mfma_f32_16x16x32_bf16 v[104:107], v[24:27], v[60:63], 0
    s_waitcnt vmcnt(3)
    v_mfma_f32_16x16x32_bf16 v[100:103], v[28:31], v[64:67], v[100:103]
    v_mfma_f32_16x16x32_bf16 v[104:107], v[32:35], v[64:67], v[104:107]
    s_waitcnt vmcnt(2)
    v_mfma_f32_16x16x32_bf16 v[100:103], v[36:39], v[68:71], v[100:103]
    v_mfma_f32_16x16x32_bf16 v[104:107], v[40:43], v[68:71], v[104:107]
    s_waitcnt vmcnt(1)
    v_mfma_f32_16x16x32_bf16 v[100:103], v[44:47], v[72:75], v[100:103]
    v_mfma_f32_16x16x32_bf16 v[104:107], v[48:51], v[72:75], v[104:107]
    s_waitcnt vmcnt(0)
    v_mfma_f32_16x16x32_bf16 v[100:103], v[52:55], v[76:79], v[100:103]
    s_nop 7
    v_add_f32_dpp v100, v104, v100 row_ror:8 row_mask:0xf bank_mask:0xf
    v_add_f32_dpp v101, v105, v101 row_ror:8 row_mask:0xf bank_mask:0xf
    v_add_f32_dpp v102, v106, v102 row_ror:8 row_mask:0xf bank_mask:0xf
    v_add_f32_dpp v103, v107, v103 row_ror:8 row_mask:0xf bank_mask:0xf
    v_mov_b32_sdwa v100, s58 dst_sel:BYTE_0 dst_unused:UNUSED_PRESERVE src0_sel:BYTE_0
    v_mov_b32_sdwa v101, s59 dst_sel:BYTE_0 dst_unused:UNUSED_PRESERVE src0_sel:BYTE_0
    v_mov_b32_sdwa v102, s60 dst_sel:BYTE_0 dst_unused:UNUSED_PRESERVE src0_sel:BYTE_0
    v_mov_b32_sdwa v103, s61 dst_sel:BYTE_0 dst_unused:UNUSED_PRESERVE src0_sel:BYTE_0
    s_mov_b32 exec_lo, 0x00ff00ff
    s_mov_b32 exec_hi, 0x00ff00ff
    s_add_u32 vcc_lo, s54, 5767168
    buffer_store_dwordx4 v[100:103], v138, s[48:51], vcc_lo offen
    buffer_store_dwordx4 v[100:103], v138, s[48:51], s54 offen sc1
    s_mov_b64 exec, -1
    s_mov_b32 exec_lo, 0x00ff00ff
    s_mov_b32 exec_hi, 0x00ff00ff
    buffer_load_dwordx4 v[192:195], v17, s[36:39], s72 offen nt
    s_mov_b64 exec, -1
    s_mov_b32 vcc_lo, 0xff00ff00
    s_mov_b32 vcc_hi, 0xff00ff00
    v_mov_b32 v18, s64
    v_mov_b32 v19, s65
    v_cndmask_b32 v18, v18, v19, vcc
    v_add_u32 v18, v18, v17
    buffer_load_dwordx4 v[176:179], v18, s[36:39], 0 offen nt
    v_mov_b32 v18, s66
    v_mov_b32 v19, s67
    v_cndmask_b32 v18, v18, v19, vcc
    v_add_u32 v18, v18, v17
    buffer_load_dwordx4 v[180:183], v18, s[36:39], 0 offen nt
    v_mov_b32 v18, s68
    v_mov_b32 v19, s69
    v_cndmask_b32 v18, v18, v19, vcc
    v_add_u32 v18, v18, v17
    buffer_load_dwordx4 v[184:187], v18, s[36:39], 0 offen nt
    v_mov_b32 v18, s70
    v_mov_b32 v19, s71
    v_cndmask_b32 v18, v18, v19, vcc
    v_add_u32 v18, v18, v17
    buffer_load_dwordx4 v[188:191], v18, s[36:39], 0 offen nt
    s_barrier
    buffer_load_dwordx4 v[140:143], v16, s[44:47], s75 offen offset:0 nt
    buffer_load_dwordx4 v[144:147], v16, s[44:47], s75 offen offset:2304 nt
    s_add_u32 s75, s75, 4608
    s_barrier
    s_barrier
    buffer_load_dwordx4 v[148:151], v16, s[44:47], s75 offen offset:0 nt
    buffer_load_dwordx4 v[152:155], v16, s[44:47], s75 offen offset:2304 nt
L_X_o2:
    ds_read_b32 v136, v136
    s_lshl_b32 s55, s2, 7
    s_add_u32 s55, s55, 7831552
    s_barrier
    ds_read_b32 v68, v134 offset:0
    ds_read_b32 v69, v134 offset:64
    ds_read_b32 v70, v134 offset:128
    s_waitcnt lgkmcnt(0)
    v_and_b32_dpp v20, v68, v4 quad_perm:[0,0,0,0] row_mask:0xf bank_mask:0xf
    v_and_b32_dpp v21, v68, v5 quad_perm:[0,0,0,0] row_mask:0xf bank_mask:0xf
    v_and_b32_dpp v22, v68, v6 quad_perm:[0,0,0,0] row_mask:0xf bank_mask:0xf
    v_and_b32_dpp v23, v68, v7 quad_perm:[0,0,0,0] row_mask:0xf bank_mask:0xf
    v_and_b32_dpp v24, v68, v4 quad_perm:[1,1,1,1] row_mask:0xf bank_mask:0xf
    v_and_b32_dpp v25, v68, v5 quad_perm:[1,1,1,1] row_mask:0xf bank_mask:0xf
    v_and_b32_dpp v26, v68, v6 quad_perm:[1,1,1,1] row_mask:0xf bank_mask:0xf
    v_and_b32_dpp v27, v68, v7 quad_perm:[1,1,1,1] row_mask:0xf bank_mask:0xf
    v_and_b32_dpp v28, v68, v4 quad_perm:[2,2,2,2] row_mask:0xf bank_mask:0xf
    v_and_b32_dpp v29, v68, v5 quad_perm:[2,2,2,2] row_mask:0xf bank_mask:0xf
    v_and_b32_dpp v30, v68, v6 quad_perm:[2,2,2,2] row_mask:0xf bank_mask:0xf
    v_and_b32_dpp v31, v68, v7 quad_perm:[2,2,2,2] row_mask:0xf bank_mask:0xf
    v_and_b32_dpp v32, v68, v4 quad_perm:[3,3,3,3] row_mask:0xf bank_mask:0xf
    v_and_b32_dpp v33, v68, v5 quad_perm:[3,3,3,3] row_mask:0xf bank_mask:0xf
    v_and_b32_dpp v34, v68, v6 quad_perm:[3,3,3,3] row_mask:0xf bank_mask:0xf
    v_and_b32_dpp v35, v68, v7 quad_perm:[3,3,3,3] row_mask:0xf bank_mask:0xf
    v_and_b32_dpp v36, v69, v4 quad_perm:[0,0,0,0] row_mask:0xf bank_mask:0xf
    v_and_b32_dpp v37, v69, v5 quad_perm:[0,0,0,0] row_mask:0xf bank_mask:0xf
    v_and_b32_dpp v38, v69, v6 quad_perm:[0,0,0,0] row_mask:0xf bank_mask:0xf
    v_and_b32_dpp v39, v69, v7 quad_perm:[0,0,0,0] row_mask:0xf bank_mask:0xf
    v_and_b32_dpp v40, v69, v4 quad_perm:[1,1,1,1] row_mask:0xf bank_mask:0xf
    v_and_b32_dpp v41, v69, v5 quad_perm:[1,1,1,1] row_mask:0xf bank_mask:0xf
    v_and_b32_dpp v42, v69, v6 quad_perm:[1,1,1,1] row_mask:0xf bank_mask:0xf
    v_and_b32_dpp v43, v69, v7 quad_perm:[1,1,1,1] row_mask:0xf bank_mask:0xf
    v_and_b32_dpp v44, v69, v4 quad_perm:[2,2,2,2] row_mask:0xf bank_mask:0xf
    v_and_b32_dpp v45, v69, v5 quad_perm:[2,2,2,2] row_mask:0xf bank_mask:0xf
    v_and_b32_dpp v46, v69, v6 quad_perm:[2,2,2,2] row_mask:0xf bank_mask:0xf
    v_and_b32_dpp v47, v69, v7 quad_perm:[2,2,2,2] row_mask:0xf bank_mask:0xf
    v_and_b32_dpp v48, v69, v4 quad_perm:[3,3,3,3] row_mask:0xf bank_mask:0xf
    v_and_b32_dpp v49, v69, v5 quad_perm:[3,3,3,3] row_mask:0xf bank_mask:0xf
    v_and_b32_dpp v50, v69, v6 quad_perm:[3,3,3,3] row_mask:0xf bank_mask:0xf
    v_and_b32_dpp v51, v69, v7 quad_perm:[3,3,3,3] row_mask:0xf bank_mask:0xf
    v_and_b32_dpp v52, v70, v4 quad_perm:[0,0,0,0] row_mask:0xf bank_mask:0xf
    v_and_b32_dpp v53, v70, v5 quad_perm:[0,0,0,0] row_mask:0xf bank_mask:0xf
    v_and_b32_dpp v54, v70, v6 quad_perm:[0,0,0,0] row_mask:0xf bank_mask:0xf
    v_and_b32_dpp v55, v70, v7 quad_perm:[0,0,0,0] row_mask:0xf bank_mask:0xf
    s_waitcnt vmcnt(8)
    s_cmp_eq_u32 s3, 4
    s_cbranch_scc1 L_X_half2
    v_mfma_f32_16x16x32_bf16 v[60:63], v[20:23], v[176:179], 0
    v_mfma_f32_16x16x32_bf16 v[60:63], v[24:27], v[180:183], v[60:63]
    v_mfma_f32_16x16x32_bf16 v[60:63], v[28:31], v[184:187], v[60:63]
    v_mfma_f32_16x16x32_bf16 v[60:63], v[32:35], v[188:191], v[60:63]
    v_mfma_f32_16x16x32_bf16 v[60:63], v[36:39], v[192:195], v[60:63]
    v_mfma_f32_16x16x32_bf16 v[60:63], v[40:43], v[196:199], v[60:63]
    v_mfma_f32_16x16x32_bf16 v[60:63], v[44:47], v[200:203], v[60:63]
    v_mfma_f32_16x16x32_bf16 v[60:63], v[48:51], v[204:207], v[60:63]
    v_mfma_f32_16x16x32_bf16 v[60:63], v[52:55], v[208:211], v[60:63]
    s_branch L_X_o3
L_X_half2:
    s_waitcnt vmcnt(4)
    v_mfma_f32_16x16x32_bf16 v[60:63], v[20:23], v[176:179], 0
    v_mfma_f32_16x16x32_bf16 v[64:67], v[24:27], v[176:179], 0
    v_mfma_f32_16x16x32_bf16 v[60:63], v[28:31], v[180:183], v[60:63]
    v_mfma_f32_16x16x32_bf16 v[64:67], v[32:35], v[180:183], v[64:67]
    v_mfma_f32_16x16x32_bf16 v[60:63], v[36:39], v[184:187], v[60:63]
    v_mfma_f32_16x16x32_bf16 v[64:67], v[40:43], v[184:187], v[64:67]
    v_mfma_f32_16x16x32_bf16 v[60:63], v[44:47], v[188:191], v[60:63]
    v_mfma_f32_16x16x32_bf16 v[64:67], v[48:51], v[188:191], v[64:67]
    v_mfma_f32_16x16x32_bf16 v[60:63], v[52:55], v[192:195], v[60:63]
L_X_o3:
    s_waitcnt lgkmcnt(0)
    s_mov_b32 s62, 0
poll_5:
    buffer_load_dword v72, v135, s[48:51], s73 offen offset:0 sc1
    buffer_load_dword v73, v135, s[48:51], s73 offen offset:256 sc1
    buffer_load_dword v74, v135, s[48:51], s73 offen offset:512 sc1
    buffer_load_dword v75, v135, s[48:51], s73 offen offset:768 sc1
    s_waitcnt vmcnt(0)
    v_xor_b32 v76, v132, v72
    v_bitop3_b32 v76, v76, v73, v132 bitop3:0xf6
    v_bitop3_b32 v76, v76, v74, v132 bitop3:0xf6
    v_bitop3_b32 v76, v76, v75, v132 bitop3:0xf6
    v_and_b32 v76, 0xff, v76
    v_cmp_ne_u32 vcc, 0, v76
    s_add_u32 s62, s62, 1
    s_cbranch_vccz done_6
    s_cmp_eq_u32 s62, 256
    s_cselect_b32 vcc_lo, 7143424, 0
    s_sub_u32 s73, s73, vcc_lo
    s_cmp_lt_u32 s62, 200000
    s_cbranch_scc1 poll_5
done_6:
    s_cmp_eq_u32 s3, 1
    s_cselect_b32 exec_lo, 0xffff, 0
    s_mov_b32 exec_hi, 0
    buffer_store_dword v137, v135, s[48:51], s55 offen sc1
    s_mov_b64 exec, -1
    v_add_f32 v72, v72, v73
    v_add_f32 v74, v74, v75
    v_add_f32 v72, v72, v74
    v_mul_f32 v72, v72, v136
    v_cvt_pk_bf16_f32 v72, v72, v72
    v_mov_b32 v73, v72
    v_mov_b32 v74, v72
    s_nop 0
    v_mov_b32_dpp v73, v72 row_shr:4 row_mask:0xf bank_mask:0xa
    v_mov_b32_dpp v74, v72 row_shl:4 row_mask:0xf bank_mask:0x5
    s_cmp_eq_u32 s3, 4
    s_cbranch_scc1 L_X_half3
    v_and_b32_dpp v20, v73, v4 quad_perm:[0,0,0,0] row_mask:0xf bank_mask:0xf
    v_and_b32_dpp v21, v73, v5 quad_perm:[0,0,0,0] row_mask:0xf bank_mask:0xf
    v_and_b32_dpp v22, v73, v6 quad_perm:[0,0,0,0] row_mask:0xf bank_mask:0xf
    v_and_b32_dpp v23, v73, v7 quad_perm:[0,0,0,0] row_mask:0xf bank_mask:0xf
    v_and_b32_dpp v24, v73, v4 quad_perm:[1,1,1,1] row_mask:0xf bank_mask:0xf
    v_and_b32_dpp v25, v73, v5 quad_perm:[1,1,1,1] row_mask:0xf bank_mask:0xf
    v_and_b32_dpp v26, v73, v6 quad_perm:[1,1,1,1] row_mask:0xf bank_mask:0xf
    v_and_b32_dpp v27, v73, v7 quad_perm:[1,1,1,1] row_mask:0xf bank_mask:0xf
    v_mfma_f32_16x16x32_bf16 v[60:63], v[20:23], v[140:143], v[60:63]
    v_and_b32_dpp v28, v73, v4 quad_perm:[2,2,2,2] row_mask:0xf bank_mask:0xf
    v_and_b32_dpp v29, v73, v5 quad_perm:[2,2,2,2] row_mask:0xf bank_mask:0xf
    v_and_b32_dpp v30, v73, v6 quad_perm:[2,2,2,2] row_mask:0xf bank_mask:0xf
    v_and_b32_dpp v31, v73, v7 quad_perm:[2,2,2,2] row_mask:0xf bank_mask:0xf
    v_mfma_f32_16x16x32_bf16 v[60:63], v[24:27], v[144:147], v[60:63]
    v_and_b32_dpp v32, v73, v4 quad_perm:[3,3,3,3] row_mask:0xf bank_mask:0xf
    v_and_b32_dpp v33, v73, v5 quad_perm:[3,3,3,3] row_mask:0xf bank_mask:0xf
    v_and_b32_dpp v34, v73, v6 quad_perm:[3,3,3,3] row_mask:0xf bank_mask:0xf
    v_and_b32_dpp v35, v73, v7 quad_perm:[3,3,3,3] row_mask:0xf bank_mask:0xf
    v_mfma_f32_16x16x32_bf16 v[60:63], v[28:31], v[148:151], v[60:63]
    v_and_b32_dpp v36, v74, v4 quad_perm:[0,0,0,0] row_mask:0xf bank_mask:0xf
    v_and_b32_dpp v37, v74, v5 quad_perm:[0,0,0,0] row_mask:0xf bank_mask:0xf
    v_and_b32_dpp v38, v74, v6 quad_perm:[0,0,0,0] row_mask:0xf bank_mask:0xf
    v_and_b32_dpp v39, v74, v7 quad_perm:[0,0,0,0] row_mask:0xf bank_mask:0xf
    v_mfma_f32_16x16x32_bf16 v[60:63], v[32:35], v[152:155], v[60:63]
    v_and_b32_dpp v40, v74, v4 quad_perm:[1,1,1,1] row_mask:0xf bank_mask:0xf
    v_and_b32_dpp v41, v74, v5 quad_perm:[1,1,1,1] row_mask:0xf bank_mask:0xf
    v_and_b32_dpp v42, v74, v6 quad_perm:[1,1,1,1] row_mask:0xf bank_mask:0xf
    v_and_b32_dpp v43, v74, v7 quad_perm:[1,1,1,1] row_mask:0xf bank_mask:0xf
    v_mfma_f32_16x16x32_bf16 v[60:63], v[36:39], v[156:159], v[60:63]
    v_and_b32_dpp v44, v74, v4 quad_perm:[2,2,2,2] row_mask:0xf bank_mask:0xf
    v_and_b32_dpp v45, v74, v5 quad_perm:[2,2,2,2] row_mask:0xf bank_mask:0xf
    v_and_b32_dpp v46, v74, v6 quad_perm:[2,2,2,2] row_mask:0xf bank_mask:0xf
    v_and_b32_dpp v47, v74, v7 quad_perm:[2,2,2,2] row_mask:0xf bank_mask:0xf
    v_mfma_f32_16x16x32_bf16 v[60:63], v[40:43], v[160:163], v[60:63]
    v_and_b32_dpp v48, v74, v4 quad_perm:[3,3,3,3] row_mask:0xf bank_mask:0xf
    v_and_b32_dpp v49, v74, v5 quad_perm:[3,3,3,3] row_mask:0xf bank_mask:0xf
    v_and_b32_dpp v50, v74, v6 quad_perm:[3,3,3,3] row_mask:0xf bank_mask:0xf
    v_and_b32_dpp v51, v74, v7 quad_perm:[3,3,3,3] row_mask:0xf bank_mask:0xf
    v_mfma_f32_16x16x32_bf16 v[60:63], v[44:47], v[164:167], v[60:63]
    s_nop 0
    v_mfma_f32_16x16x32_bf16 v[60:63], v[48:51], v[168:171], v[60:63]
    s_nop 7
    v_mov_b32_sdwa v60, s58 dst_sel:BYTE_0 dst_unused:UNUSED_PRESERVE src0_sel:BYTE_0
    v_mov_b32_sdwa v61, s59 dst_sel:BYTE_0 dst_unused:UNUSED_PRESERVE src0_sel:BYTE_0
    v_mov_b32_sdwa v62, s60 dst_sel:BYTE_0 dst_unused:UNUSED_PRESERVE src0_sel:BYTE_0
    v_mov_b32_sdwa v63, s61 dst_sel:BYTE_0 dst_unused:UNUSED_PRESERVE src0_sel:BYTE_0
    buffer_store_dwordx4 v[60:63], v138, s[48:51], s74 offen sc1
    s_branch L_X_end
L_X_half3:
    v_and_b32_dpp v20, v73, v4 quad_perm:[0,0,0,0] row_mask:0xf bank_mask:0xf
    v_and_b32_dpp v21, v73, v5 quad_perm:[0,0,0,0] row_mask:0xf bank_mask:0xf
    v_and_b32_dpp v22, v73, v6 quad_perm:[0,0,0,0] row_mask:0xf bank_mask:0xf
    v_and_b32_dpp v23, v73, v7 quad_perm:[0,0,0,0] row_mask:0xf bank_mask:0xf
    v_and_b32_dpp v24, v73, v4 quad_perm:[1,1,1,1] row_mask:0xf bank_mask:0xf
    v_and_b32_dpp v25, v73, v5 quad_perm:[1,1,1,1] row_mask:0xf bank_mask:0xf
    v_and_b32_dpp v26, v73, v6 quad_perm:[1,1,1,1] row_mask:0xf bank_mask:0xf
    v_and_b32_dpp v27, v73, v7 quad_perm:[1,1,1,1] row_mask:0xf bank_mask:0xf
    v_mfma_f32_16x16x32_bf16 v[60:63], v[20:23], v[140:143], v[60:63]
    v_and_b32_dpp v28, v73, v4 quad_perm:[2,2,2,2] row_mask:0xf bank_mask:0xf
    v_and_b32_dpp v29, v73, v5 quad_perm:[2,2,2,2] row_mask:0xf bank_mask:0xf
    v_and_b32_dpp v30, v73, v6 quad_perm:[2,2,2,2] row_mask:0xf bank_mask:0xf
    v_and_b32_dpp v31, v73, v7 quad_perm:[2,2,2,2] row_mask:0xf bank_mask:0xf
    v_mfma_f32_16x16x32_bf16 v[64:67], v[24:27], v[140:143], v[64:67]
    v_and_b32_dpp v32, v73, v4 quad_perm:[3,3,3,3] row_mask:0xf bank_mask:0xf
    v_and_b32_dpp v33, v73, v5 quad_perm:[3,3,3,3] row_mask:0xf bank_mask:0xf
    v_and_b32_dpp v34, v73, v6 quad_perm:[3,3,3,3] row_mask:0xf bank_mask:0xf
    v_and_b32_dpp v35, v73, v7 quad_perm:[3,3,3,3] row_mask:0xf bank_mask:0xf
    v_mfma_f32_16x16x32_bf16 v[60:63], v[28:31], v[144:147], v[60:63]
    v_and_b32_dpp v36, v74, v4 quad_perm:[0,0,0,0] row_mask:0xf bank_mask:0xf
    v_and_b32_dpp v37, v74, v5 quad_perm:[0,0,0,0] row_mask:0xf bank_mask:0xf
    v_and_b32_dpp v38, v74, v6 quad_perm:[0,0,0,0] row_mask:0xf bank_mask:0xf
    v_and_b32_dpp v39, v74, v7 quad_perm:[0,0,0,0] row_mask:0xf bank_mask:0xf
    v_mfma_f32_16x16x32_bf16 v[64:67], v[32:35], v[144:147], v[64:67]
    v_and_b32_dpp v40, v74, v4 quad_perm:[1,1,1,1] row_mask:0xf bank_mask:0xf
    v_and_b32_dpp v41, v74, v5 quad_perm:[1,1,1,1] row_mask:0xf bank_mask:0xf
    v_and_b32_dpp v42, v74, v6 quad_perm:[1,1,1,1] row_mask:0xf bank_mask:0xf
    v_and_b32_dpp v43, v74, v7 quad_perm:[1,1,1,1] row_mask:0xf bank_mask:0xf
    v_mfma_f32_16x16x32_bf16 v[60:63], v[36:39], v[148:151], v[60:63]
    v_and_b32_dpp v44, v74, v4 quad_perm:[2,2,2,2] row_mask:0xf bank_mask:0xf
    v_and_b32_dpp v45, v74, v5 quad_perm:[2,2,2,2] row_mask:0xf bank_mask:0xf
    v_and_b32_dpp v46, v74, v6 quad_perm:[2,2,2,2] row_mask:0xf bank_mask:0xf
    v_and_b32_dpp v47, v74, v7 quad_perm:[2,2,2,2] row_mask:0xf bank_mask:0xf
    v_mfma_f32_16x16x32_bf16 v[64:67], v[40:43], v[148:151], v[64:67]
    v_and_b32_dpp v48, v74, v4 quad_perm:[3,3,3,3] row_mask:0xf bank_mask:0xf
    v_and_b32_dpp v49, v74, v5 quad_perm:[3,3,3,3] row_mask:0xf bank_mask:0xf
    v_and_b32_dpp v50, v74, v6 quad_perm:[3,3,3,3] row_mask:0xf bank_mask:0xf
    v_and_b32_dpp v51, v74, v7 quad_perm:[3,3,3,3] row_mask:0xf bank_mask:0xf
    v_mfma_f32_16x16x32_bf16 v[60:63], v[44:47], v[152:155], v[60:63]
    s_nop 0
    v_mfma_f32_16x16x32_bf16 v[64:67], v[48:51], v[152:155], v[64:67]
    s_nop 7
    v_add_f32_dpp v60, v64, v60 row_ror:8 row_mask:0xf bank_mask:0xf
    v_add_f32_dpp v61, v65, v61 row_ror:8 row_mask:0xf bank_mask:0xf
    v_add_f32_dpp v62, v66, v62 row_ror:8 row_mask:0xf bank_mask:0xf
    v_add_f32_dpp v63, v67, v63 row_ror:8 row_mask:0xf bank_mask:0xf
    v_mov_b32_sdwa v60, s58 dst_sel:BYTE_0 dst_unused:UNUSED_PRESERVE src0_sel:BYTE_0
    v_mov_b32_sdwa v61, s59 dst_sel:BYTE_0 dst_unused:UNUSED_PRESERVE src0_sel:BYTE_0
    v_mov_b32_sdwa v62, s60 dst_sel:BYTE_0 dst_unused:UNUSED_PRESERVE src0_sel:BYTE_0
    v_mov_b32_sdwa v63, s61 dst_sel:BYTE_0 dst_unused:UNUSED_PRESERVE src0_sel:BYTE_0
    s_mov_b32 exec_lo, 0x00ff00ff
    s_mov_b32 exec_hi, 0x00ff00ff
    buffer_store_dwordx4 v[60:63], v138, s[48:51], s74 offen sc1
    s_mov_b64 exec, -1
    s_branch L_X_end
L_X_fg:
    s_cmp_eq_u32 s3, 7
    s_cbranch_scc1 L_X_fg7
    s_mov_b32 s40, s20
    s_mov_b32 s41, s21
    s_mov_b32 s42, 9216
    s_mov_b32 s43, 0x20000
    s_sub_u32 s54, s3, 5
    s_mul_i32 s52, s57, 73728
    s_mul_i32 s53, s54, 2304
    s_add_u32 s52, s52, s53
    s_mul_i32 s53, s56, 144
    s_add_u32 s52, s52, s53
    s_add_u32 s52, s52, 6356992
    s_add_u32 s64, s52, 18432
    s_add_u32 s65, s52, 36864
    s_add_u32 s66, s52, 55296
    v_mul_u32_u24 v10, 4608, v3
    v_lshl_add_u32 v10, v2, 4, v10
    v_add_u32 v14, v139, v3
    v_lshlrev_b32 v14, 1, v14
    s_lshl_b32 s53, s54, 2
    s_add_u32 s53, s53, 107008
    v_mov_b32 v16, s53
    s_mul_i32 s53, s54, 192
    s_add_u32 s53, s53, 106496
    v_lshl_add_u32 v17, v2, 2, v3
    v_lshlrev_b32 v17, 2, v17
    v_add_u32 v17, s53, v17
    s_mov_b32 exec_lo, 0x01ff01ff
    s_mov_b32 exec_hi, 0x01ff01ff
    buffer_load_ushort v15, v14, s[40:43], 0 offen
    s_barrier
    s_barrier
    ds_read_b32 v16, v16
    buffer_load_dwordx4 v[20:23], v10, s[48:51], s52 offen sc1
    buffer_load_dwordx4 v[24:27], v10, s[48:51], s64 offen sc1
    buffer_load_dwordx4 v[28:31], v10, s[48:51], s65 offen sc1
    buffer_load_dwordx4 v[32:35], v10, s[48:51], s66 offen sc1
    s_barrier
    s_mov_b32 s62, 0
    s_branch fchk_7
poll_8:
    buffer_load_dwordx4 v[20:23], v10, s[48:51], s52 offen sc1
    buffer_load_dwordx4 v[24:27], v10, s[48:51], s64 offen sc1
    buffer_load_dwordx4 v[28:31], v10, s[48:51], s65 offen sc1
    buffer_load_dwordx4 v[32:35], v10, s[48:51], s66 offen sc1
fchk_7:
    s_waitcnt vmcnt(3)
    v_xor_b32 v36, s58, v20
    v_bitop3_b32 v36, v36, v21, s59 bitop3:0xf6
    v_bitop3_b32 v36, v36, v22, s60 bitop3:0xf6
    v_bitop3_b32 v36, v36, v23, s61 bitop3:0xf6
    s_waitcnt vmcnt(2)
    v_bitop3_b32 v36, v36, v24, s58 bitop3:0xf6
    v_bitop3_b32 v36, v36, v25, s59 bitop3:0xf6
    v_bitop3_b32 v36, v36, v26, s60 bitop3:0xf6
    v_bitop3_b32 v36, v36, v27, s61 bitop3:0xf6
    s_waitcnt vmcnt(1)
    v_bitop3_b32 v36, v36, v28, s58 bitop3:0xf6
    v_bitop3_b32 v36, v36, v29, s59 bitop3:0xf6
    v_bitop3_b32 v36, v36, v30, s60 bitop3:0xf6
    v_bitop3_b32 v36, v36, v31, s61 bitop3:0xf6
    s_waitcnt vmcnt(0)
    v_bitop3_b32 v36, v36, v32, s58 bitop3:0xf6
    v_bitop3_b32 v36, v36, v33, s59 bitop3:0xf6
    v_bitop3_b32 v36, v36, v34, s60 bitop3:0xf6
    v_bitop3_b32 v36, v36, v35, s61 bitop3:0xf6
    v_and_b32 v36, 0xff, v36
    v_cmp_ne_u32 vcc, 0, v36
    s_add_u32 s62, s62, 1
    s_cbranch_vccz done_9
    s_cmp_eq_u32 s62, 256
    s_cselect_b32 vcc_lo, 5767168, 0
    s_sub_u32 s52, s52, vcc_lo
    s_sub_u32 s64, s64, vcc_lo
    s_sub_u32 s65, s65, vcc_lo
    s_sub_u32 s66, s66, vcc_lo
    s_cmp_lt_u32 s62, 200000
    s_cbranch_scc1 poll_8
done_9:
    s_mov_b64 exec, -1
    v_add_f32 v20, v20, v24
    v_add_f32 v28, v28, v32
    v_add_f32 v21, v21, v25
    v_add_f32 v29, v29, v33
    v_add_f32 v22, v22, v26
    v_add_f32 v30, v30, v34
    v_add_f32 v23, v23, v27
    v_add_f32 v31, v31, v35
    v_add_f32 v20, v20, v28
    v_add_f32 v21, v21, v29
    v_add_f32 v22, v22, v30
    v_add_f32 v23, v23, v31
    s_nop 0
    v_permlane32_swap_b32 v20, v22
    v_permlane32_swap_b32 v21, v23
    v_add_f32 v20, v20, v22
    v_add_f32 v21, v21, v23
    s_nop 1
    v_permlane16_swap_b32 v20, v21
    v_add_f32 v20, v20, v21
    v_lshlrev_b32 v15, 16, v15
    v_add_f32 v20, v20, v15
    v_mul_f32 v21, v20, v20
    v_mov_b32 v22, 3222493025
    v_fmac_f32 v22, 3184710632, v21
    v_mul_f32 v21, v22, v20
    v_exp_f32 v21, v21
    s_nop 0
    v_add_f32 v21, 1.0, v21
    v_rcp_f32 v21, v21
    s_waitcnt lgkmcnt(0)
    v_sub_f32 v16, 1.0, v16
    v_mul_f32 v20, v20, v21
    v_mul_f32 v20, v20, v16
    v_cvt_pk_bf16_f32 v20, v20, v20
    s_mov_b32 exec_lo, 0x01ff01ff
    s_mov_b32 exec_hi, 0x01ff01ff
    ds_write_b32 v17, v20
    s_mov_b64 exec, -1
    s_waitcnt lgkmcnt(0)
    s_branch L_X_fgend
L_X_fg7:
    s_lshl_b32 s54, s57, 4
    s_add_u32 s54, s54, s56
    s_mul_i32 s54, s54, 4608
    s_add_u32 s54, s54, 6356992
    v_lshlrev_b32 v41, 7, v1
    s_mov_b32 exec_hi, 15
    buffer_load_dword v42, v41, s[48:51], s54 offen sc1
    s_mov_b64 exec, -1
    s_mov_b32 s40, s26
    s_mov_b32 s41, s27
    s_mov_b32 s42, 1152
    s_mov_b32 s43, 0x20000
    v_and_b32 v9, 31, v1
    v_mul_u32_u24 v9, 36, v9
    v_lshrrev_b32 v12, 5, v1
    v_mul_u32_u24 v11, 1152, v12
    v_add_u32 v11, v11, v9
    buffer_load_dwordx4 v[20:23], v11, s[36:39], 0 offen
    buffer_load_dwordx4 v[24:27], v11, s[36:39], 0 offen offset:16
    buffer_load_dword v28, v11, s[36:39], 0 offen offset:32
    buffer_load_dwordx4 v[32:35], v9, s[40:43], 0 offen
    buffer_load_dwordx4 v[36:39], v9, s[40:43], 0 offen offset:16
    buffer_load_dword v40, v9, s[40:43], 0 offen offset:32
    v_mov_b32 v13, 0
    v_lshlrev_b32 v10, 2, v12
    v_add_u32 v10, 107008, v10
    s_waitcnt vmcnt(0)
    v_dot2_f32_bf16 v13, v20, v32, v13
    v_dot2_f32_bf16 v13, v21, v33, v13
    v_dot2_f32_bf16 v13, v22, v34, v13
    v_dot2_f32_bf16 v13, v23, v35, v13
    v_dot2_f32_bf16 v13, v24, v36, v13
    v_dot2_f32_bf16 v13, v25, v37, v13
    v_dot2_f32_bf16 v13, v26, v38, v13
    v_dot2_f32_bf16 v13, v27, v39, v13
    v_dot2_f32_bf16 v13, v28, v40, v13
    s_nop 2
    v_add_f32_dpp v13, v13, v13 quad_perm:[1,0,3,2] row_mask:0xf bank_mask:0xf
    s_nop 1
    v_add_f32_dpp v13, v13, v13 quad_perm:[2,3,0,1] row_mask:0xf bank_mask:0xf
    s_nop 1
    v_add_f32_dpp v13, v13, v13 row_half_mirror row_mask:0xf bank_mask:0xf
    s_nop 1
    v_add_f32_dpp v13, v13, v13 row_mirror row_mask:0xf bank_mask:0xf
    v_mov_b32 v14, v13
    s_nop 1
    v_permlane16_swap_b32 v13, v14
    v_add_f32 v13, v13, v14
    v_mul_f32 v13, 3216550459, v13
    v_exp_f32 v13, v13
    s_nop 0
    v_add_f32 v13, 1.0, v13
    v_rcp_f32 v13, v13
    s_nop 0
    ds_write_b32 v10, v13
    s_waitcnt lgkmcnt(0)
    s_mov_b32 exec_lo, 0x01010101
    s_mov_b32 exec_hi, 0x01010101
    buffer_load_dword v20, v8, s[48:51], s73 offen sc1
    s_mov_b64 exec, -1
    s_barrier
    s_barrier
    s_barrier
    s_waitcnt vmcnt(0)
L_X_fgend:
    s_barrier
L_X_end:
    s_endpgm
L_Y_main:
    s_and_b32 s54, s3, 3
    s_lshr_b32 s55, s3, 2
    v_and_b32 v9, 7, v2
    v_lshlrev_b32 v9, 1, v9
    v_lshrrev_b32 v10, 3, v2
    v_or_b32 v9, v9, v10
    v_lshlrev_b32 v9, 4, v9
    v_lshl_add_u32 v9, v3, 8, v9
    v_lshl_add_u32 v9, v2, 10, v9
    s_lshl_b32 s52, s54, 14
    v_add_u32 v13, s52, v9
    s_lshl_b32 s52, s55, 14
    s_add_u32 s52, s52, 65536
    v_add_u32 v20, s52, v9
    v_xor_b32 v21, 16, v20
    v_xor_b32 v22, 32, v20
    v_xor_b32 v23, 48, v20
    v_xor_b32 v24, 64, v20
    v_xor_b32 v25, 80, v20
    v_xor_b32 v26, 96, v20
    v_xor_b32 v27, 112, v20
    v_xor_b32 v28, 128, v20
    v_xor_b32 v29, 144, v20
    v_xor_b32 v30, 160, v20
    v_xor_b32 v31, 176, v20
    v_xor_b32 v32, 192, v20
    v_xor_b32 v33, 208, v20
    v_xor_b32 v34, 224, v20
    v_xor_b32 v35, 240, v20
    v_lshrrev_b32 v9, 2, v1
    v_and_b32 v10, 7, v9
    v_lshlrev_b32 v10, 1, v10
    v_lshrrev_b32 v11, 3, v9
    v_or_b32 v10, v10, v11
    v_bfe_u32 v11, v1, 1, 1
    v_xor_b32 v10, v10, v11
    v_lshlrev_b32 v10, 4, v10
    v_lshl_add_u32 v10, v9, 10, v10
    v_and_b32 v11, 1, v1
    v_lshl_add_u32 v10, v11, 3, v10
    s_lshl_b32 s52, s54, 8
    v_add_u32 v36, s52, v10
    v_xor_b32 v37, 32, v36
    v_xor_b32 v38, 64, v36
    v_xor_b32 v39, 96, v36
    v_xor_b32 v40, 128, v36
    v_xor_b32 v41, 160, v36
    v_xor_b32 v42, 192, v36
    v_xor_b32 v43, 224, v36
    v_and_b32 v208, 7, v1
    v_mul_u32_u24 v208, 37, v208
    v_add_u32 v208, s58, v208
    v_and_b32 v208, 0xff, v208
    v_lshl_or_b32 v208, v208, 15, v208
    v_lshrrev_b32 v209, 2, v208
    v_lshrrev_b32 v210, 4, v208
    v_lshrrev_b32 v211, 6, v208
    s_bitcmp1_b32 s2, 0
    s_cselect_b32 s52, 0xff, 0
    v_and_b32 v212, 7, v1
    v_mul_u32_u24 v212, 37, v212
    v_add_u32 v212, s58, v212
    v_xor_b32 v212, s52, v212
    v_and_b32 v212, 0xff, v212
    v_lshl_or_b32 v212, v212, 15, v212
    v_lshrrev_b32 v213, 2, v212
    v_lshrrev_b32 v214, 4, v212
    v_lshrrev_b32 v215, 6, v212
    s_sub_u32 s56, s35, 4
    v_bfe_u32 v9, v1, 3, 1
    v_lshlrev_b32 v14, 10, v9
    v_and_b32 v11, 3, v1
    v_lshl_add_u32 v14, v11, 6, v14
    v_lshl_add_u32 v14, v3, 4, v14
    s_and_b32 s54, s3, 3
    s_lshr_b32 s55, s3, 2
    s_lshl_b32 s68, s54, 8
    s_lshl_b32 s69, s34, 11
    s_add_u32 s68, s68, s69
    s_add_u32 s68, s68, 393216
    v_lshl_add_u32 v47, v9, 6, v3
    v_mul_u32_u24 v47, 256, v47
    v_and_b32 v11, 7, v1
    v_lshl_add_u32 v47, v11, 4, v47
    s_lshl_b32 s69, s34, 2
    s_add_u32 s69, s69, s56
    s_lshl_b32 s66, s34, 12
    s_lshl_b32 s67, s56, 8
    s_add_u32 s66, s66, s67
    s_add_u32 s67, s66, 7602176
    s_add_u32 s66, s66, 458752
    s_mul_i32 s69, s69, 32896
    s_mul_i32 vcc_lo, s54, 4096
    s_add_u32 s69, s69, vcc_lo
    s_lshl_b32 vcc_lo, s55, 7
    s_add_u32 s69, s69, vcc_lo
    s_add_u32 s69, s69, 2097152
    v_bfe_u32 v11, v1, 2, 1
    v_lshlrev_b32 v11, 1, v11
    v_xor_b32 v11, s54, v11
    v_lshl_add_u32 v14, v11, 8, v14
    s_lshl_b32 s68, s34, 11
    s_add_u32 s68, s68, 393216
    s_bfe_u32 s52, s2, 0x10006
    s_lshl_b32 s52, s52, 15
    s_lshl_b32 s53, s3, 12
    s_add_u32 s52, s52, s53
    s_add_u32 s52, s52, 327680
    s_add_u32 s53, s53, 65536
    s_and_b32 vcc_lo, s3, 1
    s_lshl_b32 vcc_lo, vcc_lo, 7
    s_bfe_u32 vcc_hi, s3, 0x10001
    s_lshl_b32 vcc_hi, vcc_hi, 4
    s_or_b32 vcc_lo, vcc_lo, vcc_hi
    v_xor_b32 v16, vcc_lo, v8
    v_add_u32 v16, s53, v16
    v_xor_b32 v17, 32, v16
    v_xor_b32 v18, 64, v16
    v_xor_b32 v19, 0x60, v16
    s_lshl_b32 s73, s55, 12
    s_add_u32 s73, s73, 98304
    v_add_u32 v10, s73, v8
    s_lshl_b32 s73, s54, 10
    v_add_u32 v11, s73, v10
    v_mul_u32_u24 v12, 526336, v3
    v_lshl_add_u32 v12, v2, 4, v12
    s_sub_u32 s73, s2, 128
    s_lshl_b32 s53, s73, 4
    v_lshlrev_b32 v15, 11, v1
    s_lshl_b32 vcc_lo, s55, 15
    s_add_u32 s53, s53, vcc_lo
    s_add_u32 s53, s53, 393216
    s_mul_i32 s74, s73, 256
    s_mul_i32 vcc_lo, s55, 2105344
    s_add_u32 s74, s74, vcc_lo
    s_mul_i32 vcc_lo, s54, 32896
    s_add_u32 s74, s74, vcc_lo
    s_add_u32 s74, s74, 2097152
    s_lshl_b32 s73, s73, 8
    s_lshl_b32 vcc_lo, s55, 7
    s_add_u32 s73, s73, vcc_lo
    s_add_u32 s73, s73, 7733248
    s_mov_b32 s40, s12
    s_mov_b32 s41, s13
    s_mov_b32 s42, 4194304
    s_mov_b32 s43, 0x20000
    s_sub_u32 s64, s35, 4
    s_lshl_b32 s64, s64, 20
    s_lshl_b32 s65, s54, 15
    s_add_u32 s64, s64, s65
    s_lshl_b32 s65, s34, 8
    s_add_u32 s64, s64, s65
    v_lshlrev_b32 v9, 1, v3
    v_xor_b32 v9, v9, v2
    v_lshlrev_b32 v9, 4, v9
    v_lshl_add_u32 v44, v3, 17, v9
    v_xor_b32 v45, 0x80, v44
    s_lshl_b32 s65, s54, 13
    s_add_u32 s65, s65, 107520
    s_bfe_u32 s73, s2, 0x30004
    s_mul_i32 s73, s73, 2304
    s_and_b32 vcc_lo, s2, 15
    s_lshl_b32 vcc_lo, vcc_lo, 2
    s_add_u32 s73, s73, vcc_lo
    s_add_u32 s73, s73, 7929856
    v_mul_u32_u24 v46, 18432, v1
    v_mov_b32 v248, 0x3f803f80
    v_mov_b32 v252, s58
    v_mov_b32 v249, 0x3f803f80
    v_mov_b32 v253, s58
    v_mov_b32 v250, 0x3f803f80
    v_mov_b32 v254, s58
    v_mov_b32 v251, 0x3f803f80
    v_mov_b32 v255, s58
    s_waitcnt vmcnt(12)
    s_barrier
    s_cmp_lg_u32 s54, 0
    s_cbranch_scc1 nos_10
    v_xor_b32 v9, 0, v13
    ds_read_b128 v[48:51], v9
    v_xor_b32 v9, 16, v13
    ds_read_b128 v[52:55], v9
    v_xor_b32 v9, 32, v13
    ds_read_b128 v[56:59], v9
    v_xor_b32 v9, 48, v13
    ds_read_b128 v[60:63], v9
    v_xor_b32 v9, 64, v13
    ds_read_b128 v[64:67], v9
    v_xor_b32 v9, 80, v13
    ds_read_b128 v[68:71], v9
    v_xor_b32 v9, 96, v13
    ds_read_b128 v[72:75], v9
    v_xor_b32 v9, 112, v13
    ds_read_b128 v[76:79], v9
    v_xor_b32 v9, 128, v13
    ds_read_b128 v[80:83], v9
    v_xor_b32 v9, 144, v13
    ds_read_b128 v[84:87], v9
    v_xor_b32 v9, 160, v13
    ds_read_b128 v[88:91], v9
    v_xor_b32 v9, 176, v13
    ds_read_b128 v[92:95], v9
    v_xor_b32 v9, 192, v13
    ds_read_b128 v[96:99], v9
    v_xor_b32 v9, 208, v13
    ds_read_b128 v[100:103], v9
    v_xor_b32 v9, 224, v13
    ds_read_b128 v[104:107], v9
    v_xor_b32 v9, 240, v13
    ds_read_b128 v[108:111], v9
nos_10:
    ds_read_b64_tr_b16 v[112:113], v36 offset:0
    ds_read_b64_tr_b16 v[120:121], v37 offset:0
    ds_read_b64_tr_b16 v[128:129], v38 offset:0
    ds_read_b64_tr_b16 v[136:137], v39 offset:0
    ds_read_b64_tr_b16 v[144:145], v40 offset:0
    ds_read_b64_tr_b16 v[152:153], v41 offset:0
    ds_read_b64_tr_b16 v[160:161], v42 offset:0
    ds_read_b64_tr_b16 v[168:169], v43 offset:0
    s_waitcnt vmcnt(8)
    s_barrier
    s_cmp_lg_u32 s54, 1
    s_cbranch_scc1 nos_12
    v_xor_b32 v9, 0, v13
    ds_read_b128 v[48:51], v9
    v_xor_b32 v9, 16, v13
    ds_read_b128 v[52:55], v9
    v_xor_b32 v9, 32, v13
    ds_read_b128 v[56:59], v9
    v_xor_b32 v9, 48, v13
    ds_read_b128 v[60:63], v9
    v_xor_b32 v9, 64, v13
    ds_read_b128 v[64:67], v9
    v_xor_b32 v9, 80, v13
    ds_read_b128 v[68:71], v9
    v_xor_b32 v9, 96, v13
    ds_read_b128 v[72:75], v9
    v_xor_b32 v9, 112, v13
    ds_read_b128 v[76:79], v9
    v_xor_b32 v9, 128, v13
    ds_read_b128 v[80:83], v9
    v_xor_b32 v9, 144, v13
    ds_read_b128 v[84:87], v9
    v_xor_b32 v9, 160, v13
    ds_read_b128 v[88:91], v9
    v_xor_b32 v9, 176, v13
    ds_read_b128 v[92:95], v9
    v_xor_b32 v9, 192, v13
    ds_read_b128 v[96:99], v9
    v_xor_b32 v9, 208, v13
    ds_read_b128 v[100:103], v9
    v_xor_b32 v9, 224, v13
    ds_read_b128 v[104:107], v9
    v_xor_b32 v9, 240, v13
    ds_read_b128 v[108:111], v9
nos_12:
    ds_read_b64_tr_b16 v[114:115], v36 offset:16384
    ds_read_b64_tr_b16 v[122:123], v37 offset:16384
    ds_read_b64_tr_b16 v[130:131], v38 offset:16384
    ds_read_b64_tr_b16 v[138:139], v39 offset:16384
    ds_read_b64_tr_b16 v[146:147], v40 offset:16384
    ds_read_b64_tr_b16 v[154:155], v41 offset:16384
    ds_read_b64_tr_b16 v[162:163], v42 offset:16384
    ds_read_b64_tr_b16 v[170:171], v43 offset:16384
    s_waitcnt vmcnt(4)
    s_barrier
    s_cmp_lg_u32 s54, 2
    s_cbranch_scc1 nos_14
    v_xor_b32 v9, 0, v13
    ds_read_b128 v[48:51], v9
    v_xor_b32 v9, 16, v13
    ds_read_b128 v[52:55], v9
    v_xor_b32 v9, 32, v13
    ds_read_b128 v[56:59], v9
    v_xor_b32 v9, 48, v13
    ds_read_b128 v[60:63], v9
    v_xor_b32 v9, 64, v13
    ds_read_b128 v[64:67], v9
    v_xor_b32 v9, 80, v13
    ds_read_b128 v[68:71], v9
    v_xor_b32 v9, 96, v13
    ds_read_b128 v[72:75], v9
    v_xor_b32 v9, 112, v13
    ds_read_b128 v[76:79], v9
    v_xor_b32 v9, 128, v13
    ds_read_b128 v[80:83], v9
    v_xor_b32 v9, 144, v13
    ds_read_b128 v[84:87], v9
    v_xor_b32 v9, 160, v13
    ds_read_b128 v[88:91], v9
    v_xor_b32 v9, 176, v13
    ds_read_b128 v[92:95], v9
    v_xor_b32 v9, 192, v13
    ds_read_b128 v[96:99], v9
    v_xor_b32 v9, 208, v13
    ds_read_b128 v[100:103], v9
    v_xor_b32 v9, 224, v13
    ds_read_b128 v[104:107], v9
    v_xor_b32 v9, 240, v13
    ds_read_b128 v[108:111], v9
nos_14:
    ds_read_b64_tr_b16 v[116:117], v36 offset:32768
    ds_read_b64_tr_b16 v[124:125], v37 offset:32768
    ds_read_b64_tr_b16 v[132:133], v38 offset:32768
    ds_read_b64_tr_b16 v[140:141], v39 offset:32768
    ds_read_b64_tr_b16 v[148:149], v40 offset:32768
    ds_read_b64_tr_b16 v[156:157], v41 offset:32768
    ds_read_b64_tr_b16 v[164:165], v42 offset:32768
    ds_read_b64_tr_b16 v[172:173], v43 offset:32768
    buffer_load_dwordx4 v[216:219], v8, s[48:51], s52 offen offset:0 sc1
    buffer_load_dwordx4 v[220:223], v8, s[48:51], s52 offen offset:1024 sc1
    buffer_load_dwordx4 v[224:227], v8, s[48:51], s52 offen offset:2048 sc1
    buffer_load_dwordx4 v[228:231], v8, s[48:51], s52 offen offset:3072 sc1
    s_waitcnt vmcnt(4)
    s_barrier
    s_cmp_lg_u32 s54, 3
    s_cbranch_scc1 nos_16
    v_xor_b32 v9, 0, v13
    ds_read_b128 v[48:51], v9
    v_xor_b32 v9, 16, v13
    ds_read_b128 v[52:55], v9
    v_xor_b32 v9, 32, v13
    ds_read_b128 v[56:59], v9
    v_xor_b32 v9, 48, v13
    ds_read_b128 v[60:63], v9
    v_xor_b32 v9, 64, v13
    ds_read_b128 v[64:67], v9
    v_xor_b32 v9, 80, v13
    ds_read_b128 v[68:71], v9
    v_xor_b32 v9, 96, v13
    ds_read_b128 v[72:75], v9
    v_xor_b32 v9, 112, v13
    ds_read_b128 v[76:79], v9
    v_xor_b32 v9, 128, v13
    ds_read_b128 v[80:83], v9
    v_xor_b32 v9, 144, v13
    ds_read_b128 v[84:87], v9
    v_xor_b32 v9, 160, v13
    ds_read_b128 v[88:91], v9
    v_xor_b32 v9, 176, v13
    ds_read_b128 v[92:95], v9
    v_xor_b32 v9, 192, v13
    ds_read_b128 v[96:99], v9
    v_xor_b32 v9, 208, v13
    ds_read_b128 v[100:103], v9
    v_xor_b32 v9, 224, v13
    ds_read_b128 v[104:107], v9
    v_xor_b32 v9, 240, v13
    ds_read_b128 v[108:111], v9
nos_16:
    ds_read_b64_tr_b16 v[118:119], v36 offset:49152
    ds_read_b64_tr_b16 v[126:127], v37 offset:49152
    ds_read_b64_tr_b16 v[134:135], v38 offset:49152
    ds_read_b64_tr_b16 v[142:143], v39 offset:49152
    ds_read_b64_tr_b16 v[150:151], v40 offset:49152
    ds_read_b64_tr_b16 v[158:159], v41 offset:49152
    ds_read_b64_tr_b16 v[166:167], v42 offset:49152
    ds_read_b64_tr_b16 v[174:175], v43 offset:49152
    s_mov_b32 s62, 0
    s_branch qw_20
poll_19:
    buffer_load_dwordx4 v[216:219], v8, s[48:51], s52 offen offset:0 sc1
    buffer_load_dwordx4 v[220:223], v8, s[48:51], s52 offen offset:1024 sc1
    buffer_load_dwordx4 v[224:227], v8, s[48:51], s52 offen offset:2048 sc1
    buffer_load_dwordx4 v[228:231], v8, s[48:51], s52 offen offset:3072 sc1
    s_mov_b64 exec, -1
qw_20:
    s_waitcnt vmcnt(3)
    ds_write_b128 v16, v[216:219] offset:0
    v_xor_b32 v9, v208, v216
    v_bitop3_b32 v9, v9, v217, v209 bitop3:0xf6
    v_bitop3_b32 v9, v9, v218, v210 bitop3:0xf6
    v_bitop3_b32 v9, v9, v219, v211 bitop3:0xf6
    s_waitcnt vmcnt(2)
    ds_write_b128 v17, v[220:223] offset:1024
    v_bitop3_b32 v9, v9, v220, v208 bitop3:0xf6
    v_bitop3_b32 v9, v9, v221, v209 bitop3:0xf6
    v_bitop3_b32 v9, v9, v222, v210 bitop3:0xf6
    v_bitop3_b32 v9, v9, v223, v211 bitop3:0xf6
    s_waitcnt vmcnt(1)
    ds_write_b128 v18, v[224:227] offset:2048
    v_bitop3_b32 v9, v9, v224, v208 bitop3:0xf6
    v_bitop3_b32 v9, v9, v225, v209 bitop3:0xf6
    v_bitop3_b32 v9, v9, v226, v210 bitop3:0xf6
    v_bitop3_b32 v9, v9, v227, v211 bitop3:0xf6
    s_waitcnt vmcnt(0)
    ds_write_b128 v19, v[228:231] offset:3072
    v_bitop3_b32 v9, v9, v228, v208 bitop3:0xf6
    v_bitop3_b32 v9, v9, v229, v209 bitop3:0xf6
    v_bitop3_b32 v9, v9, v230, v210 bitop3:0xf6
    v_bitop3_b32 v9, v9, v231, v211 bitop3:0xf6
qchk_18:
    v_and_b32 v9, 0x10001, v9
    v_cmp_ne_u32 vcc, 0, v9
    s_add_u32 s62, s62, 1
    s_cbranch_vccz done_21
    s_wqm_b64 exec, vcc
    s_cmp_lt_u32 s62, 200000
    s_cbranch_scc1 poll_19
    s_mov_b64 exec, -1
done_21:
    s_mov_b32 s52, s74
    v_mov_b32 v9, 0x10001
    s_waitcnt lgkmcnt(0)
    s_barrier
    ds_read_b128 v[216:219], v20
    ds_read_b128 v[220:223], v21
    s_cmp_eq_u32 s55, 0
    s_cbranch_scc1 L_Y_s
    s_mov_b32 vcc_hi, m0
    s_add_u32 m0, s65, 4096
    s_add_u32 vcc_lo, s64, 16384
    buffer_load_dwordx4 v44, s[40:43], vcc_lo offen nt lds
    s_add_u32 m0, s65, 5120
    s_add_u32 vcc_lo, s64, 540672
    buffer_load_dwordx4 v44, s[40:43], vcc_lo offen nt lds
    s_add_u32 m0, s65, 6144
    s_add_u32 vcc_lo, s64, 24576
    buffer_load_dwordx4 v45, s[40:43], vcc_lo offen nt lds
    s_add_u32 m0, s65, 7168
    s_add_u32 vcc_lo, s64, 548864
    buffer_load_dwordx4 v45, s[40:43], vcc_lo offen nt lds
    s_mov_b32 m0, vcc_hi
    s_barrier
    s_setprio 1
L_Y_s:
    ds_read_b128 v[224:227], v22
    ds_read_b128 v[228:231], v23
    ds_read_b128 v[232:235], v24
    ds_read_b128 v[236:239], v25
    ds_read_b128 v[240:243], v26
    ds_read_b128 v[244:247], v27
    s_waitcnt lgkmcnt(7)
    v_mfma_f32_16x16x32_bf16 v[176:179], v[48:51], v[216:219], 0
    ds_read_b128 v[216:219], v28
    s_waitcnt lgkmcnt(7)
    v_mfma_f32_16x16x32_bf16 v[176:179], v[52:55], v[220:223], v[176:179]
    ds_read_b128 v[220:223], v29
    s_waitcnt lgkmcnt(7)
    v_mfma_f32_16x16x32_bf16 v[176:179], v[56:59], v[224:227], v[176:179]
    ds_read_b128 v[224:227], v30
    s_waitcnt lgkmcnt(7)
    v_mfma_f32_16x16x32_bf16 v[176:179], v[60:63], v[228:231], v[176:179]
    ds_read_b128 v[228:231], v31
    s_waitcnt lgkmcnt(7)
    v_mfma_f32_16x16x32_bf16 v[176:179], v[64:67], v[232:235], v[176:179]
    ds_read_b128 v[232:235], v32
    s_waitcnt lgkmcnt(7)
    v_mfma_f32_16x16x32_bf16 v[176:179], v[68:71], v[236:239], v[176:179]
    ds_read_b128 v[236:239], v33
    s_waitcnt lgkmcnt(7)
    v_mfma_f32_16x16x32_bf16 v[176:179], v[72:75], v[240:243], v[176:179]
    ds_read_b128 v[240:243], v34
    s_waitcnt lgkmcnt(7)
    v_mfma_f32_16x16x32_bf16 v[176:179], v[76:79], v[244:247], v[176:179]
    ds_read_b128 v[244:247], v35
    s_waitcnt lgkmcnt(7)
    v_mfma_f32_16x16x32_bf16 v[176:179], v[80:83], v[216:219], v[176:179]
    s_waitcnt lgkmcnt(6)
    v_mfma_f32_16x16x32_bf16 v[176:179], v[84:87], v[220:223], v[176:179]
    s_waitcnt lgkmcnt(5)
    v_mfma_f32_16x16x32_bf16 v[176:179], v[88:91], v[224:227], v[176:179]
    s_waitcnt lgkmcnt(4)
    v_mfma_f32_16x16x32_bf16 v[176:179], v[92:95], v[228:231], v[176:179]
    s_waitcnt lgkmcnt(3)
    v_mfma_f32_16x16x32_bf16 v[176:179], v[96:99], v[232:235], v[176:179]
    s_waitcnt lgkmcnt(2)
    v_mfma_f32_16x16x32_bf16 v[176:179], v[100:103], v[236:239], v[176:179]
    s_waitcnt lgkmcnt(1)
    v_mfma_f32_16x16x32_bf16 v[176:179], v[104:107], v[240:243], v[176:179]
    s_waitcnt lgkmcnt(0)
    v_mfma_f32_16x16x32_bf16 v[176:179], v[108:111], v[244:247], v[176:179]
    s_nop 7
    ds_write_b128 v11, v[176:179]
    s_waitcnt lgkmcnt(0)
    s_barrier
    ds_read_b128 v[48:51], v10 offset:0
    ds_read_b128 v[52:55], v10 offset:1024
    ds_read_b128 v[56:59], v10 offset:2048
    ds_read_b128 v[60:63], v10 offset:3072
    s_waitcnt lgkmcnt(2)
    v_max3_f32 v64, v48, v49, v50
    v_max3_f32 v65, v51, v52, v53
    v_max3_f32 v64, v64, v54, v55
    s_waitcnt lgkmcnt(0)
    v_max3_f32 v65, v65, v56, v57
    v_max3_f32 v64, v64, v58, v59
    v_max3_f32 v65, v65, v60, v61
    v_max3_f32 v64, v64, v62, v63
    v_max_f32 v64, v64, v65
    v_mov_b32 v65, v64
    s_nop 1
    v_permlane32_swap_b32 v64, v65
    v_max_f32 v64, v64, v65
    v_mov_b32 v65, v64
    s_nop 1
    v_permlane16_swap_b32 v64, v65
    v_max_f32 v64, v64, v65
    s_cmp_eq_u32 s55, 0
    s_cbranch_scc0 L_Y_p
    s_barrier
L_Y_p:
    v_pk_add_f32 v[48:49], v[48:49], v[64:65] op_sel_hi:[1,0] neg_lo:[0,1] neg_hi:[0,1]
    v_pk_add_f32 v[50:51], v[50:51], v[64:65] op_sel_hi:[1,0] neg_lo:[0,1] neg_hi:[0,1]
    v_pk_add_f32 v[52:53], v[52:53], v[64:65] op_sel_hi:[1,0] neg_lo:[0,1] neg_hi:[0,1]
    v_pk_add_f32 v[54:55], v[54:55], v[64:65] op_sel_hi:[1,0] neg_lo:[0,1] neg_hi:[0,1]
    v_exp_f32 v48, v48
    v_exp_f32 v49, v49
    v_exp_f32 v50, v50
    v_exp_f32 v51, v51
    v_exp_f32 v52, v52
    v_exp_f32 v53, v53
    v_exp_f32 v54, v54
    v_exp_f32 v55, v55
    v_pk_add_f32 v[56:57], v[56:57], v[64:65] op_sel_hi:[1,0] neg_lo:[0,1] neg_hi:[0,1]
    v_pk_add_f32 v[58:59], v[58:59], v[64:65] op_sel_hi:[1,0] neg_lo:[0,1] neg_hi:[0,1]
    v_pk_add_f32 v[60:61], v[60:61], v[64:65] op_sel_hi:[1,0] neg_lo:[0,1] neg_hi:[0,1]
    v_pk_add_f32 v[62:63], v[62:63], v[64:65] op_sel_hi:[1,0] neg_lo:[0,1] neg_hi:[0,1]
    v_cvt_pk_bf16_f32 v72, v48, v49
    v_cvt_pk_bf16_f32 v73, v50, v51
    v_cvt_pk_bf16_f32 v74, v52, v53
    v_cvt_pk_bf16_f32 v75, v54, v55
    s_cmp_eq_u32 s3, 7
    s_cbranch_scc0 L_Y_noh
    s_mov_b32 exec_lo, 65535
    s_mov_b32 exec_hi, 0
    buffer_store_dword v252, v46, s[48:51], s73 offen sc1
    s_mov_b64 exec, -1
L_Y_noh:
    v_mfma_f32_16x16x32_bf16 v[176:179], v[72:75], v[112:115], 0
    v_exp_f32 v56, v56
    v_mfma_f32_16x16x32_bf16 v[180:183], v[72:75], v[120:123], 0
    v_exp_f32 v57, v57
    v_mfma_f32_16x16x32_bf16 v[184:187], v[72:75], v[128:131], 0
    v_exp_f32 v58, v58
    v_mfma_f32_16x16x32_bf16 v[188:191], v[72:75], v[136:139], 0
    v_exp_f32 v59, v59
    v_cvt_pk_bf16_f32 v76, v56, v57
    v_mfma_f32_16x16x32_bf16 v[192:195], v[72:75], v[144:147], 0
    v_exp_f32 v60, v60
    v_mfma_f32_16x16x32_bf16 v[196:199], v[72:75], v[152:155], 0
    v_exp_f32 v61, v61
    v_cvt_pk_bf16_f32 v77, v58, v59
    v_mfma_f32_16x16x32_bf16 v[200:203], v[72:75], v[160:163], 0
    v_exp_f32 v62, v62
    v_mfma_f32_16x16x32_bf16 v[204:207], v[72:75], v[168:171], 0
    v_exp_f32 v63, v63
    v_cvt_pk_bf16_f32 v78, v60, v61
    v_mov_b32 v66, s58
    v_cvt_pk_bf16_f32 v79, v62, v63
    s_cmp_eq_u32 s54, 0
    s_cbranch_scc0 L_Y_nol
    v_mfma_f32_16x16x32_bf16 v[68:71], v[248:251], v[72:75], 0
    v_mfma_f32_16x16x32_bf16 v[68:71], v[248:251], v[76:79], v[68:71]
L_Y_nol:
    v_mfma_f32_16x16x32_bf16 v[176:179], v[76:79], v[116:119], v[176:179]
    v_mfma_f32_16x16x32_bf16 v[180:183], v[76:79], v[124:127], v[180:183]
    v_mfma_f32_16x16x32_bf16 v[184:187], v[76:79], v[132:135], v[184:187]
    v_mfma_f32_16x16x32_bf16 v[188:191], v[76:79], v[140:143], v[188:191]
    s_cmp_eq_u32 s54, 0
    s_cselect_b32 vcc_lo, 0xffff, 0
    v_mfma_f32_16x16x32_bf16 v[192:195], v[76:79], v[148:151], v[192:195]
    s_nop 0
    v_mov_b32 v65, v68
    v_mfma_f32_16x16x32_bf16 v[196:199], v[76:79], v[156:159], v[196:199]
    s_mov_b32 exec_lo, vcc_lo
    s_mov_b32 exec_hi, 0
    buffer_store_dwordx4 v[64:67], v15, s[48:51], s53 offen sc1
L_Y_nost2:
    s_mov_b64 exec, -1
    v_mfma_f32_16x16x32_bf16 v[200:203], v[76:79], v[164:167], v[200:203]
    v_cvt_pk_bf16_f32 v80, v176, v180
    v_cvt_pk_bf16_f32 v84, v177, v181
    v_cvt_pk_bf16_f32 v88, v178, v182
    v_mfma_f32_16x16x32_bf16 v[204:207], v[76:79], v[172:175], v[204:207]
    v_cvt_pk_bf16_f32 v92, v179, v183
    v_bfi_b32 v80, v9, v212, v80
    v_bfi_b32 v84, v9, v212, v84
    v_bfi_b32 v88, v9, v212, v88
    v_bfi_b32 v92, v9, v212, v92
    v_cvt_pk_bf16_f32 v81, v184, v188
    v_cvt_pk_bf16_f32 v85, v185, v189
    v_cvt_pk_bf16_f32 v89, v186, v190
    v_cvt_pk_bf16_f32 v93, v187, v191
    v_bfi_b32 v81, v9, v213, v81
    v_bfi_b32 v85, v9, v213, v85
    v_bfi_b32 v89, v9, v213, v89
    v_bfi_b32 v93, v9, v213, v93
    v_cvt_pk_bf16_f32 v82, v192, v196
    v_cvt_pk_bf16_f32 v86, v193, v197
    v_cvt_pk_bf16_f32 v90, v194, v198
    v_cvt_pk_bf16_f32 v94, v195, v199
    v_bfi_b32 v82, v9, v214, v82
    v_bfi_b32 v86, v9, v214, v86
    v_bfi_b32 v90, v9, v214, v90
    v_bfi_b32 v94, v9, v214, v94
    v_cvt_pk_bf16_f32 v83, v200, v204
    v_bfi_b32 v83, v9, v215, v83
    buffer_store_dwordx4 v[80:83], v12, s[48:51], s52 offen sc1
    s_add_u32 s52, s52, 131584
    v_cvt_pk_bf16_f32 v87, v201, v205
    v_bfi_b32 v87, v9, v215, v87
    buffer_store_dwordx4 v[84:87], v12, s[48:51], s52 offen sc1
    s_add_u32 s52, s52, 131584
    v_cvt_pk_bf16_f32 v91, v202, v206
    v_bfi_b32 v91, v9, v215, v91
    buffer_store_dwordx4 v[88:91], v12, s[48:51], s52 offen sc1
    s_add_u32 s52, s52, 131584
    v_cvt_pk_bf16_f32 v95, v203, v207
    v_bfi_b32 v95, v9, v215, v95
    buffer_store_dwordx4 v[92:95], v12, s[48:51], s52 offen sc1
    v_xor_b32 v13, 0x100, v14
    s_setprio 0
    s_and_b32 s64, s2, 15
    s_lshl_b32 s64, s64, 3
    s_add_u32 s64, s64, s3
    s_mul_i32 s64, s64, 2304
    s_add_u32 s64, s64, 7929856
    s_mov_b32 s70, s58
    s_mov_b32 s62, 0
    s_load_dwordx16 s[4:19], s[48:49], s64 glc
    v_bfe_u32 v9, v1, 2, 2
    v_lshl_add_u32 v134, v3, 3, v9
    v_lshlrev_b32 v134, 8, v134
    v_and_b32 v11, 1, v3
    v_lshl_add_u32 v9, v11, 2, v9
    v_lshlrev_b32 v9, 1, v9
    v_bfe_u32 v11, v1, 1, 1
    s_lshl_b32 s52, s3, 1
    v_add_u32 v11, s52, v11
    v_xor_b32 v9, v9, v11
    v_lshl_add_u32 v134, v9, 4, v134
    v_and_b32 v9, 1, v1
    v_lshl_add_u32 v134, v9, 3, v134
    v_add_u32 v134, 107520, v134
    v_bfe_u32 v9, v1, 3, 1
    v_and_b32 v11, 7, v1
    v_and_b32 v122, 1, v3
    v_mul_u32_u24 v122, 0xff, v122
    v_and_b32 v124, 7, v1
    v_mul_u32_u24 v124, 37, v124
    v_add_u32 v124, s58, v124
    v_xor_b32 v124, v122, v124
    v_and_b32 v124, 0xff, v124
    v_lshl_or_b32 v124, v124, 15, v124
    v_lshrrev_b32 v125, 2, v124
    v_lshrrev_b32 v126, 4, v124
    v_lshrrev_b32 v127, 6, v124
    v_mul_u32_u24 v122, 1088, v9
    v_lshl_add_u32 v122, v11, 4, v122
    v_and_b32 v123, 1, v3
    v_lshl_add_u32 v122, v123, 3, v122
    s_mul_i32 s71, s54, 272
    s_lshl_b32 s72, s55, 7
    s_add_u32 s71, s71, s72
    s_add_u32 s71, s71, 65536
    v_add_u32 v122, s71, v122
    v_lshlrev_b32 v128, 5, v9
    s_lshl_b32 s71, s54, 2
    s_add_u32 s71, s71, 67840
    v_add_u32 v128, s71, v128
    v_lshlrev_b32 v129, 5, v123
    v_add_u32 v129, 67840, v129
    v_mul_u32_u24 v130, 272, v11
    v_lshl_add_u32 v130, v3, 4, v130
    v_add_u32 v130, 65536, v130
    v_lshlrev_b32 v131, 5, v3
    v_lshl_add_u32 v131, v11, 2, v131
    v_lshl_add_u32 v131, v9, 6, v131
    s_lshr_b32 s71, s3, 1
    s_lshl_b32 s71, s71, 10
    s_and_b32 s72, s3, 1
    s_lshl_b32 s72, s72, 7
    s_add_u32 s71, s71, s72
    v_add_u32 v131, s71, v131
    v_and_b32 v132, 3, v1
    v_mul_u32_u24 v132, 37, v132
    v_add_u32 v132, s58, v132
    v_mov_b32 v133, 1
    s_mov_b32 s71, s70
    s_branch L_cf2
    s_mov_b32 s71, s70
L_cf:
    s_load_dwordx16 s[4:19], s[48:49], s64 glc
L_cf2:
    s_add_u32 s62, s62, 1
    s_cmp_ge_u32 s62, 200000
    s_cbranch_scc1 L_cfd
    s_waitcnt lgkmcnt(0)
    s_cmp_lg_u64 s[4:5], s[70:71]
    s_cbranch_scc1 L_cf
    s_cmp_lg_u64 s[6:7], s[70:71]
    s_cbranch_scc1 L_cf
    s_cmp_lg_u64 s[8:9], s[70:71]
    s_cbranch_scc1 L_cf
    s_cmp_lg_u64 s[10:11], s[70:71]
    s_cbranch_scc1 L_cf
    s_cmp_lg_u64 s[12:13], s[70:71]
    s_cbranch_scc1 L_cf
    s_cmp_lg_u64 s[14:15], s[70:71]
    s_cbranch_scc1 L_cf
    s_cmp_lg_u64 s[16:17], s[70:71]
    s_cbranch_scc1 L_cf
    s_cmp_lg_u64 s[18:19], s[70:71]
    s_cbranch_scc1 L_cf
L_cfd:
    s_waitcnt lgkmcnt(0)
L_Y_v:
    s_waitcnt vmcnt(4)
    s_barrier
    buffer_load_dwordx4 v[52:55], v14, s[48:51], s68 offen sc1
    buffer_load_dwordx4 v[92:95], v13, s[48:51], s68 offen sc1
    s_barrier
    buffer_load_dwordx4 v[56:59], v47, s[48:51], s69 offen offset:0 sc1
    buffer_load_dwordx4 v[60:63], v47, s[48:51], s69 offen offset:1024 sc1
    buffer_load_dwordx4 v[64:67], v47, s[48:51], s69 offen offset:2048 sc1
    buffer_load_dwordx4 v[68:71], v47, s[48:51], s69 offen offset:3072 sc1
    ds_read_b64_tr_b16 v[20:21], v134 offset:0
    ds_read_b64_tr_b16 v[22:23], v134 offset:1024
    ds_read_b64_tr_b16 v[24:25], v134 offset:8192
    ds_read_b64_tr_b16 v[26:27], v134 offset:9216
    ds_read_b64_tr_b16 v[28:29], v134 offset:16384
    ds_read_b64_tr_b16 v[30:31], v134 offset:17408
    ds_read_b64_tr_b16 v[32:33], v134 offset:24576
    ds_read_b64_tr_b16 v[34:35], v134 offset:25600
    s_mov_b32 s62, 0
    s_waitcnt vmcnt(4)
    s_branch schk_22
poll_23:
    buffer_load_dwordx4 v[52:55], v14, s[48:51], s68 offen sc1
    buffer_load_dwordx4 v[92:95], v13, s[48:51], s68 offen sc1
    s_waitcnt vmcnt(0)
schk_22:
    v_xor_b32 v49, s58, v54
    v_bitop3_b32 v49, v49, v94, s58 bitop3:0xf6
    v_max_f32 v50, v52, v92
    v_and_b32 v49, -1, v49
    v_cmp_ne_u32 vcc, 0, v49
    s_add_u32 s62, s62, 1
    s_cbranch_vccz done_24
    s_cmp_lt_u32 s62, 200000
    s_cbranch_scc1 poll_23
done_24:
    v_max_f32_dpp v50, v50, v50 quad_perm:[1,0,3,2] row_mask:0xf bank_mask:0xf
    s_nop 1
    v_max_f32_dpp v50, v50, v50 quad_perm:[2,3,0,1] row_mask:0xf bank_mask:0xf
    s_nop 1
    v_max_f32_dpp v50, v50, v50 row_half_mirror row_mask:0xf bank_mask:0xf
    v_mov_b32 v51, v50
    s_nop 1
    v_permlane32_swap_b32 v50, v51
    v_max_f32 v50, v50, v51
    v_mov_b32 v51, v50
    s_nop 1
    v_permlane16_swap_b32 v50, v51
    v_max_f32 v50, v50, v51
    v_sub_f32 v52, v52, v50
    v_sub_f32 v92, v92, v50
    v_exp_f32 v52, v52
    v_exp_f32 v92, v92
    v_mul_f32 v51, v52, v53
    v_fmac_f32 v51, v92, v93
    s_nop 1
    v_add_f32_dpp v51, v51, v51 quad_perm:[1,0,3,2] row_mask:0xf bank_mask:0xf
    s_nop 1
    v_add_f32_dpp v51, v51, v51 quad_perm:[2,3,0,1] row_mask:0xf bank_mask:0xf
    s_nop 1
    v_add_f32_dpp v51, v51, v51 row_half_mirror row_mask:0xf bank_mask:0xf
    v_mov_b32 v55, v51
    s_nop 1
    v_permlane32_swap_b32 v51, v55
    v_add_f32 v51, v51, v55
    v_mov_b32 v55, v51
    s_nop 1
    v_permlane16_swap_b32 v51, v55
    v_add_f32 v51, v51, v55
    v_rcp_f32 v51, v51
    s_nop 0
    v_mul_f32 v51, v51, v52
    v_cvt_pk_bf16_f32 v51, v51, v51
    s_nop 1
    v_mov_b32_dpp v51, v51 row_shr:4 row_mask:0xf bank_mask:0xa
    s_nop 1
    v_and_b32_dpp v72, v51, v4 quad_perm:[0,0,0,0] row_mask:0xf bank_mask:0xf
    v_and_b32_dpp v73, v51, v5 quad_perm:[0,0,0,0] row_mask:0xf bank_mask:0xf
    v_and_b32_dpp v74, v51, v6 quad_perm:[0,0,0,0] row_mask:0xf bank_mask:0xf
    v_and_b32_dpp v75, v51, v7 quad_perm:[0,0,0,0] row_mask:0xf bank_mask:0xf
    v_and_b32_dpp v76, v51, v4 quad_perm:[1,1,1,1] row_mask:0xf bank_mask:0xf
    v_and_b32_dpp v77, v51, v5 quad_perm:[1,1,1,1] row_mask:0xf bank_mask:0xf
    v_and_b32_dpp v78, v51, v6 quad_perm:[1,1,1,1] row_mask:0xf bank_mask:0xf
    v_and_b32_dpp v79, v51, v7 quad_perm:[1,1,1,1] row_mask:0xf bank_mask:0xf
    v_and_b32_dpp v80, v51, v4 quad_perm:[2,2,2,2] row_mask:0xf bank_mask:0xf
    v_and_b32_dpp v81, v51, v5 quad_perm:[2,2,2,2] row_mask:0xf bank_mask:0xf
    v_and_b32_dpp v82, v51, v6 quad_perm:[2,2,2,2] row_mask:0xf bank_mask:0xf
    v_and_b32_dpp v83, v51, v7 quad_perm:[2,2,2,2] row_mask:0xf bank_mask:0xf
    v_and_b32_dpp v84, v51, v4 quad_perm:[3,3,3,3] row_mask:0xf bank_mask:0xf
    v_and_b32_dpp v85, v51, v5 quad_perm:[3,3,3,3] row_mask:0xf bank_mask:0xf
    v_and_b32_dpp v86, v51, v6 quad_perm:[3,3,3,3] row_mask:0xf bank_mask:0xf
    v_and_b32_dpp v87, v51, v7 quad_perm:[3,3,3,3] row_mask:0xf bank_mask:0xf
    s_mov_b32 s62, 0
    s_branch cchk_25
poll_26:
    buffer_load_dwordx4 v[56:59], v47, s[48:51], s69 offen offset:0 sc1
    buffer_load_dwordx4 v[60:63], v47, s[48:51], s69 offen offset:1024 sc1
    buffer_load_dwordx4 v[64:67], v47, s[48:51], s69 offen offset:2048 sc1
    buffer_load_dwordx4 v[68:71], v47, s[48:51], s69 offen offset:3072 sc1
    s_mov_b64 exec, -1
cchk_25:
    s_waitcnt vmcnt(3)
    v_mfma_f32_16x16x32_bf16 v[88:91], v[72:75], v[56:59], 0
    v_xor_b32 v49, v124, v56
    v_bitop3_b32 v49, v49, v57, v125 bitop3:0xf6
    v_bitop3_b32 v49, v49, v58, v126 bitop3:0xf6
    v_bitop3_b32 v49, v49, v59, v127 bitop3:0xf6
    s_waitcnt vmcnt(2)
    v_mfma_f32_16x16x32_bf16 v[88:91], v[76:79], v[60:63], v[88:91]
    v_bitop3_b32 v49, v49, v60, v124 bitop3:0xf6
    v_bitop3_b32 v49, v49, v61, v125 bitop3:0xf6
    v_bitop3_b32 v49, v49, v62, v126 bitop3:0xf6
    v_bitop3_b32 v49, v49, v63, v127 bitop3:0xf6
    s_waitcnt vmcnt(1)
    v_mfma_f32_16x16x32_bf16 v[88:91], v[80:83], v[64:67], v[88:91]
    v_bitop3_b32 v49, v49, v64, v124 bitop3:0xf6
    v_bitop3_b32 v49, v49, v65, v125 bitop3:0xf6
    v_bitop3_b32 v49, v49, v66, v126 bitop3:0xf6
    v_bitop3_b32 v49, v49, v67, v127 bitop3:0xf6
    s_waitcnt vmcnt(0)
    v_mfma_f32_16x16x32_bf16 v[88:91], v[84:87], v[68:71], v[88:91]
    v_bitop3_b32 v49, v49, v68, v124 bitop3:0xf6
    v_bitop3_b32 v49, v49, v69, v125 bitop3:0xf6
    v_bitop3_b32 v49, v49, v70, v126 bitop3:0xf6
    v_bitop3_b32 v49, v49, v71, v127 bitop3:0xf6
    v_and_b32 v49, 0x10001, v49
    v_cmp_ne_u32 vcc, 0, v49
    s_add_u32 s62, s62, 1
    s_cbranch_vccz done_27
    s_wqm_b64 exec, vcc
    s_cmp_lt_u32 s62, 200000
    s_cbranch_scc1 poll_26
    s_mov_b64 exec, -1
done_27:
    v_cvt_pk_bf16_f32 v88, v88, v89
    v_cvt_pk_bf16_f32 v89, v90, v91
    s_mov_b32 exec_lo, 0x00ff00ff
    s_mov_b32 exec_hi, 0xff00ff00
    ds_write_b64 v122, v[88:89]
    s_mov_b64 exec, -1
L_Y_b4:
    s_waitcnt lgkmcnt(0)
    s_barrier
    ds_read_b128 v[56:59], v130 offset:0
    ds_read_b128 v[60:63], v130 offset:64
    ds_read_b128 v[64:67], v130 offset:128
    ds_read_b128 v[68:71], v130 offset:192
    s_waitcnt lgkmcnt(3)
    v_mfma_f32_16x16x32_bf16 v[88:91], v[56:59], v[20:23], 0
    s_waitcnt lgkmcnt(2)
    v_mfma_f32_16x16x32_bf16 v[88:91], v[60:63], v[24:27], v[88:91]
    s_waitcnt lgkmcnt(1)
    v_mfma_f32_16x16x32_bf16 v[88:91], v[64:67], v[28:31], v[88:91]
    s_waitcnt lgkmcnt(0)
    v_mfma_f32_16x16x32_bf16 v[88:91], v[68:71], v[32:35], v[88:91]
    s_nop 7
    v_add_f32 v50, v88, v89
    v_add_f32 v51, v90, v91
    v_add_f32 v50, v50, v51
    v_mov_b32_sdwa v50, v132 dst_sel:BYTE_0 dst_unused:UNUSED_PRESERVE src0_sel:BYTE_0
    s_mov_b32 exec_hi, 0
    buffer_store_dword v50, v131, s[48:51], s67 offen
    buffer_store_dword v50, v131, s[48:51], s66 offen sc1
    s_mov_b64 exec, -1
    s_sub_u32 s2, s2, 128
    s_cmp_ge_u32 s2, 72
    s_cbranch_scc1 L_Y_end
    s_cmp_ge_u32 s2, 36
    s_cselect_b32 s54, 1, 0
    s_mul_i32 s55, s54, 36
    s_sub_u32 s55, s2, s55
    s_mul_i32 s52, s3, 73728
    s_mul_i32 s53, s54, 2304
    s_add_u32 s52, s52, s53
    s_lshl_b32 s53, s55, 6
    s_add_u32 s52, s52, s53
    s_add_u32 s52, s52, 1179648
    v_lshrrev_b32 v9, 2, v1
    v_mul_u32_u24 v10, 4608, v9
    v_and_b32 v11, 3, v1
    v_lshl_add_u32 v10, v11, 4, v10
    v_lshl_add_u32 v13, v3, 2, v11
    v_lshlrev_b32 v13, 5, v13
    s_lshl_b32 s53, s3, 2
    s_add_u32 s53, s53, 67968
    v_add_u32 v13, s53, v13
    s_mov_b32 s40, s24
    s_mov_b32 s41, s25
    s_mov_b32 s42, 1152
    s_mov_b32 s43, 0x20000
    s_mov_b32 s44, s28
    s_mov_b32 s45, s29
    s_mov_b32 s46, 2304
    s_mov_b32 s47, 0x20000
    v_mov_b32 v15, 0
    s_cmp_lg_u32 s3, 0
    s_cbranch_scc1 L_Y_rx
    s_lshl_b32 s53, s55, 2
    v_add_u32 v14, s53, v11
    v_lshrrev_b32 v15, 5, v14
    v_lshlrev_b32 v15, 7, v15
    v_and_b32 v16, 15, v14
    v_lshl_add_u32 v15, v16, 3, v15
    v_bfe_u32 v16, v14, 4, 1
    v_lshl_add_u32 v15, v16, 2, v15
    v_and_b32 v16, 7, v14
    v_lshlrev_b32 v16, 3, v16
    v_bfe_u32 v17, v14, 3, 1
    v_lshl_add_u32 v16, v17, 2, v16
    v_add_u32 v16, 512, v16
    v_cmp_gt_u32 vcc, 128, v14
    s_nop 1
    v_cndmask_b32 v15, v16, v15, vcc
    v_bfe_u32 v14, v1, 2, 2
    v_add_u32 v15, v15, v14
    v_lshlrev_b32 v15, 1, v15
    buffer_load_ushort v16, v15, s[40:43], 0 offen
    s_lshl_b32 s53, s54, 2
    s_add_u32 s53, s53, 107008
    v_mov_b32 v17, s53
    ds_read_b32 v17, v17
    v_lshlrev_b32 v18, 5, v2
    v_add_u32 v18, 67968, v18
    s_mul_i32 s54, s54, 1152
L_Y_rx:
    s_add_u32 s4, s2, 0
    s_and_b32 s4, s4, 15
    s_lshl_b32 s64, s3, 4
    s_add_u32 s4, s4, s64
    s_lshl_b32 s4, s4, 7
    s_add_u32 s4, s4, 7831552
    s_add_u32 s5, s2, 8
    s_and_b32 s5, s5, 15
    s_lshl_b32 s64, s3, 4
    s_add_u32 s5, s5, s64
    s_lshl_b32 s5, s5, 7
    s_add_u32 s5, s5, 7831552
    s_mov_b32 s62, 0
sp_28:
    s_load_dword s12, s[48:49], s4 glc
    s_load_dword s13, s[48:49], s5 glc
    s_add_u32 s62, s62, 1
    s_cmp_ge_u32 s62, 200000
    s_cbranch_scc1 spd_29
    s_waitcnt lgkmcnt(0)
    s_cmp_lg_u32 s12, s58
    s_cbranch_scc1 sp_28
    s_cmp_lg_u32 s13, s58
    s_cbranch_scc1 sp_28
spd_29:
    s_waitcnt lgkmcnt(0)
    s_mov_b32 s62, 0
poll_30:
    buffer_load_dwordx4 v[20:23], v10, s[48:51], s52 offen sc1
    s_mov_b64 exec, -1
    s_waitcnt vmcnt(0)
    v_xor_b32 v24, s58, v20
    v_bitop3_b32 v24, v24, v21, s59 bitop3:0xf6
    v_bitop3_b32 v24, v24, v22, s60 bitop3:0xf6
    v_bitop3_b32 v24, v24, v23, s61 bitop3:0xf6
    v_and_b32 v24, 0xff, v24
    v_cmp_ne_u32 vcc, 0, v24
    s_add_u32 s62, s62, 1
    s_cbranch_vccz done_31
    s_wqm_b64 exec, vcc
    s_cmp_lt_u32 s62, 200000
    s_cbranch_scc1 poll_30
    s_mov_b64 exec, -1
done_31:
    v_permlane32_swap_b32 v20, v22
    v_permlane32_swap_b32 v21, v23
    v_add_f32 v20, v20, v22
    v_add_f32 v21, v21, v23
    s_nop 1
    v_permlane16_swap_b32 v20, v21
    v_add_f32 v20, v20, v21
    s_nop 1
    v_add_f32_dpp v20, v20, v20 row_ror:4 row_mask:0xf bank_mask:0xf
    s_nop 1
    v_add_f32_dpp v20, v20, v20 row_ror:8 row_mask:0xf bank_mask:0xf
    ds_write_b32 v13, v20
    s_waitcnt lgkmcnt(0)
    s_barrier
    s_cmp_lg_u32 s3, 0
    s_cbranch_scc1 L_Y_end
    ds_read_b128 v[20:23], v18
    ds_read_b128 v[24:27], v18 offset:16
    v_lshlrev_b32 v16, 16, v16
    v_sub_f32 v17, 1.0, v17
    v_mul_f32 v16, v16, v17
    s_waitcnt lgkmcnt(0)
    v_add_f32 v20, v20, v24
    v_add_f32 v21, v21, v25
    v_add_f32 v22, v22, v26
    v_add_f32 v23, v23, v27
    v_add_f32 v20, v20, v21
    v_add_f32 v22, v22, v23
    v_add_f32 v20, v20, v16
    v_add_f32 v20, v20, v22
    v_cvt_pk_bf16_f32 v20, v20, v20
    s_mov_b64 exec, 0xffff
    buffer_store_short v20, v15, s[44:47], s54 offen
    s_cmp_lg_u32 s2, 0
    s_cbranch_scc1 L_Y_end
    s_mov_b64 exec, 1
    v_mov_b32 v21, s58
    v_mov_b32 v22, 0
    buffer_store_dword v21, v22, s[48:51], 0 offen offset:0 sc1
L_Y_end:
    s_endpgm
L_exit:
    s_endpgm
.section .rodata,"a"
.p2align 6
.amdhsa_kernel gated_mix__compressed_kv_cla__dense_activation_gelu__decode_kernel
  .amdhsa_next_free_vgpr 256
  .amdhsa_next_free_sgpr 102
  .amdhsa_accum_offset 256
  .amdhsa_group_segment_fixed_size 0
  .amdhsa_kernarg_size 120
  .amdhsa_user_sgpr_count 2
  .amdhsa_user_sgpr_kernarg_segment_ptr 1
  .amdhsa_system_sgpr_workgroup_id_x 1
.end_amdhsa_kernel
```
